```python
import torch

def _softmax(x, axis=-1):
    return torch.softmax(x, dim=axis)
def _gelu(x):
    return torch.nn.functional.gelu(x, approximate="tanh")
def _silu(x):
    return torch.nn.functional.silu(x)
def _sigmoid(x):
    return torch.sigmoid(x)
def _layernorm(x, axis=-1, eps=1e-5):
    m = x.mean(dim=axis, keepdim=True)
    v = x.var(dim=axis, keepdim=True, unbiased=False)
    return (x - m) / torch.sqrt(v + eps)
def _scatter_add(tgt, idx, src, axis=0):
    return tgt.clone().index_add_(axis, idx, src)
def _segment_sum(src, seg, n):
    out = torch.zeros((n,) + src.shape[1:], dtype=src.dtype)
    return out.index_add_(0, seg, src)
def _pad(x, pw):
    flat = tuple(v for pair in reversed(pw) for v in pair)
    return torch.nn.functional.pad(x, flat)

kernel_name = 'gated_mix__ssm_conv_s4d__glu_gated_geglu__prompt'

def setup_inputs():

    _w = (lambda a: (lambda t: t.to(torch.bfloat16) if t.is_floating_point() else t)(torch.as_tensor(a)))
    def _A_setup():
        Bsz, L, D, N = 1, 2048, 512, 128
        return {
            "u": _w((lambda *s: torch.randn(*s, dtype=torch.bfloat16) * 0.05)(Bsz, L, D)),
            "log_A_real": _w((lambda *s: torch.randn(*s, dtype=torch.bfloat16) * 6.4)(D, N) * 0.5),
            "A_imag": _w((lambda *s: torch.randn(*s, dtype=torch.bfloat16) * 0.05)(D, N) * 3.14),
            "C_real": _w((lambda *s: torch.randn(*s, dtype=torch.bfloat16) * 0.05)(D, N) / N ** 0.5),
            "C_imag": _w((lambda *s: torch.randn(*s, dtype=torch.bfloat16) * 0.05)(D, N) / N ** 0.5),
            "log_dt": _w((lambda *s: torch.randn(*s, dtype=torch.bfloat16) * 0.05)(D) * 0.5 - 4.0),
            "D_skip": _w((lambda *s: torch.randn(*s, dtype=torch.bfloat16) * 0.05)(D)),
        }
    _A_in = _A_setup()

    def _B_setup():
        B, S, Dm, Df = 1, 2048, 512, 1376
        return {
            "x": _w((lambda *s: torch.randn(*s, dtype=torch.bfloat16) * 0.05)(B, S, Dm)),
            "w_gate": _w((lambda *s: torch.randn(*s, dtype=torch.bfloat16) * 1.6)(Dm, Df) * (Dm ** -0.5)),
            "w_up": _w((lambda *s: torch.randn(*s, dtype=torch.bfloat16) * 1.6)(Dm, Df) * (Dm ** -0.5)),
            "w_down": _w((lambda *s: torch.randn(*s, dtype=torch.bfloat16) * 1.6)(Df, Dm) * (Df ** -0.5)),
        }
    _B_in = _B_setup()

    return {
        "A_u": _A_in["u"],
        "A_log_A_real": _A_in["log_A_real"],
        "A_A_imag": _A_in["A_imag"],
        "A_C_real": _A_in["C_real"],
        "A_C_imag": _A_in["C_imag"],
        "A_log_dt": _A_in["log_dt"],
        "A_D_skip": _A_in["D_skip"],
        "B_x": _B_in["x"],
        "B_w_gate": _B_in["w_gate"],
        "B_w_up": _B_in["w_up"],
        "B_w_down": _B_in["w_down"],
        "gate_w": _w((lambda *s: torch.randn(*s, dtype=torch.bfloat16) * 0.05)(512) * 16.0),
    }

def reference(A_u, A_log_A_real, A_A_imag, A_C_real, A_C_imag, A_log_dt, A_D_skip, B_x, B_w_gate, B_w_up, B_w_down, gate_w):
    def _A_ref(u, log_A_real, A_imag, C_real, C_imag, log_dt, D_skip):
        L = u.shape[1]
        dt = torch.exp(log_dt)
        A = -torch.exp(log_A_real) + 1j * A_imag
        C = (C_real + 1j * C_imag) * dt[:, None]
        pos = (lambda x, dt: x.to(dt))(torch.arange(L), log_dt.dtype)
        P = torch.exp((A * dt[:, None])[:, :, None] * pos[None, None, :])
        K = 2.0 * torch.einsum("dn,dnl->dl", C, P).real
        L2 = 2 * L
        u_t = (lambda x, *d: x.permute(*d))(u, 0, 2, 1)
        Kf = (lambda x, *a, **k: torch.fft.rfft(x.float(), *a, **k))(K, L2)
        Uf = (lambda x, *a, **k: torch.fft.rfft(x.float(), *a, **k))(u_t, L2)
        y = (lambda x, *a, **k: torch.fft.irfft(x, *a, **k).to(torch.bfloat16))(Uf * Kf[None, :, :], L2)[:, :, :L]
        y = (lambda x, *d: x.permute(*d))(y, 0, 2, 1)
        return y + u * D_skip[None, None, :]

    def _B_ref(x, w_gate, w_up, w_down):
        g = torch.einsum("bsd,df->bsf", x, w_gate)
        u = torch.einsum("bsd,df->bsf", x, w_up)
        h = _gelu(g) * u
        return torch.einsum("bsf,fd->bsd", h, w_down)

    x = A_u
    g = _sigmoid((x * gate_w).sum(-1, keepdims=True))
    a = _A_ref(x, A_log_A_real, A_A_imag, A_C_real, A_C_imag, A_log_dt, A_D_skip)
    b = _B_ref(x, B_w_gate, B_w_up, B_w_down)
    return g * a + (1 - g) * b
```

```asm
; @launch grid=(256,1,1) block=(256,1,1) lds=163840
.amdgcn_target "amdgcn-amd-amdhsa--gfx950"
.text
.globl gated_mix__ssm_conv_s4d__glu_gated_geglu__prompt_kernel
.p2align 8
.type gated_mix__ssm_conv_s4d__glu_gated_geglu__prompt_kernel,@function
gated_mix__ssm_conv_s4d__glu_gated_geglu__prompt_kernel:
  s_cmp_ge_u32 s2, 256
  s_cbranch_scc1 L_end
  s_load_dwordx16 s[4:19], s[0:1], 0
  s_load_dwordx8 s[20:27], s[0:1], 64
  s_load_dwordx4 s[28:31], s[0:1], 96
  s_load_dwordx2 s[32:33], s[0:1], 112
  s_lshr_b32 s81, s2, 3
  s_and_b32 s38, s81, 7
  s_getpc_b64 s[84:85]
L_pc:
  s_mul_i32 s80, s38, 2304
  v_min_u32 v2, 17, v0
  v_lshl_add_u32 v2, v2, 7, s80
  v_min_u32 v2, L_codeend-L_pc-4, v2
  global_load_dword v8, v2, s[84:85]
  s_lshl_b32 s83, s2, 9
  v_lshl_add_u32 v32, v0, 1, s83
  s_lshl_b32 s83, s2, 2
  v_lshrrev_b32 v33, 7, v0
  v_lshl_add_u32 v33, v33, 1, s83
  v_bfe_u32 v34, v0, 4, 1
  v_lshl_add_u32 v34, v34, 1, s83
  v_mov_b32 v35, 0x00a30000
  v_lshrrev_b32 v2, 6, v0
  v_and_b32 v1, 63, v0
  v_readfirstlane_b32 s34, v2
  s_and_b32 s80, s2, 7
  s_lshr_b32 s82, s81, 3
  s_and_b32 s35, s80, 1
  s_lshl_b32 s35, s35, 3
  s_add_u32 s35, s35, s38
  s_waitcnt lgkmcnt(0)
  global_load_ushort v72, v32, s[6:7]
  global_load_ushort v76, v33, s[14:15]
  global_load_ushort v73, v32, s[8:9]
  global_load_ushort v74, v32, s[10:11]
  global_load_ushort v75, v32, s[12:13]
  global_load_ushort v77, v34, s[16:17]
  global_load_dword v78, v35, s[32:33] sc1
  s_lshr_b32 s36, s80, 1
  s_lshl_b32 s36, s36, 2
  s_add_u32 s36, s36, s82
  s_lshl_b32 s37, s80, 2
  s_add_u32 s37, s37, s82
  s_lshl_b32 s83, s35, 2
  s_add_u32 s83, s83, s34
  s_lshl_b32 s83, s83, 15
  v_lshrrev_b32 v36, 3, v1
  v_lshrrev_b32 v37, 4, v1
  v_and_b32 v38, 7, v1
  v_xor_b32 v37, v37, v38
  v_lshlrev_b32 v36, 10, v36
  v_lshl_add_u32 v36, v37, 4, v36
  v_add_u32 v10, s83, v36
  v_xor_b32 v11, 64, v10
  v_add_u32 v11, 7168, v11
  v_add_u32 v12, 14336, v10
  v_add_u32 v13, 14336, v11
  s_add_u32 s79, s36, s35
  s_and_b32 s79, s79, 7
  s_lshl_b32 s64, s79, 7
  s_lshl_b32 s72, s34, 12
  s_mov_b32 s75, 67328
  s_mov_b64 s[40:41], s[4:5]
  s_mov_b32 s42, 2097152
  s_mov_b32 s43, 0x20000
  s_cmp_eq_u32 s36, 15
  s_cselect_b64 vcc, -1, 0
  s_cbranch_vccnz L_gld0
  s_add_u32 m0, s75, s72
  s_nop 0
  buffer_load_dwordx4 v10, s[40:43], s64 offen lds
  buffer_load_dwordx4 v11, s[40:43], s64 offen offset:1024 lds
  buffer_load_dwordx4 v12, s[40:43], s64 offen offset:2048 lds
  buffer_load_dwordx4 v13, s[40:43], s64 offen offset:3072 lds
  s_mul_i32 s83, s34, 192
  s_mul_i32 s84, s36, 192
  v_add_u32 v36, s83, v1
  v_mul_u32_u24 v37, 43691, v36
  v_lshrrev_b32 v37, 19, v37
  v_mul_u32_u24 v38, 12, v37
  v_sub_u32 v38, v36, v38
  v_mul_u32_u24 v37, 2752, v37
  v_lshl_add_u32 v37, v38, 4, v37
  v_add_u32 v14, s84, v37
  v_add_u32 v5, s84, v37
  s_add_u32 s83, s83, 64
  s_sub_u32 s84, s84, 1024
  v_add_u32 v36, s83, v1
  v_mul_u32_u24 v37, 43691, v36
  v_lshrrev_b32 v37, 19, v37
  v_mul_u32_u24 v38, 12, v37
  v_sub_u32 v38, v36, v38
  v_mul_u32_u24 v37, 2752, v37
  v_lshl_add_u32 v37, v38, 4, v37
  v_add_u32 v15, s84, v37
  v_add_u32 v6, s84, v37
  s_add_u32 s83, s83, 64
  s_sub_u32 s84, s84, 1024
  v_add_u32 v36, s83, v1
  v_mul_u32_u24 v37, 43691, v36
  v_lshrrev_b32 v37, 19, v37
  v_mul_u32_u24 v38, 12, v37
  v_sub_u32 v38, v36, v38
  v_mul_u32_u24 v37, 2752, v37
  v_lshl_add_u32 v37, v38, 4, v37
  v_add_u32 v16, s84, v37
  v_add_u32 v7, s84, v37
  s_mul_i32 s65, s79, 176128
  s_mul_i32 s73, s34, 3072
  s_add_u32 s74, s73, 28704
  s_add_u32 s73, s73, 16384
  s_mov_b64 s[44:45], s[20:21]
  s_mov_b32 s46, 1409024
  s_mov_b32 s47, 0x20000
  s_mov_b64 s[48:49], s[22:23]
  s_mov_b32 s50, 1409024
  s_mov_b32 s51, 0x20000
  s_mov_b32 s66, 128
  s_mov_b32 s101, 1024
  s_mov_b32 s68, 176128
  s_mov_b32 s69, 1409024
  v_mov_b32 v9, 0
  s_add_u32 m0, s75, s73
  s_nop 0
  buffer_load_dwordx4 v14, s[44:47], s65 offen lds
  buffer_load_dwordx4 v15, s[44:47], s65 offen offset:1024 lds
  buffer_load_dwordx4 v16, s[44:47], s65 offen offset:2048 lds
L_setup:
  v_and_b32 v128, 15, v1
  v_lshrrev_b32 v129, 4, v1
  v_and_b32 v130, 31, v1
  v_lshrrev_b32 v131, 5, v1
  v_and_b32 v132, 3, v1
  v_bfe_u32 v133, v1, 4, 1
  v_bfe_u32 v134, v1, 2, 2
  v_lshlrev_b32 v135, 4, v1
  s_mul_i32 s95, s34, 10240
  s_lshr_b32 s11, s34, 1
  s_and_b32 s12, s34, 1
  s_mul_i32 s82, s34, 16416
  s_mov_b32 s13, s82
  s_mul_i32 s83, s34, 3072
  s_add_u32 s83, s83, 149760
  v_mul_u32_u24 v136, 288, v128
  v_lshl_add_u32 v136, v129, 4, v136
  v_add_u32 v56, s82, v136
  v_and_b32 v137, 1, v129
  v_lshlrev_b32 v136, 9, v131
  v_lshl_add_u32 v136, v137, 4, v136
  v_lshl_add_u32 v136, v128, 5, v136
  v_add_u32 v57, s83, v136
  v_sub_u32 v137, 4, v131
  v_lshlrev_b32 v136, v137, v128
  v_lshl_add_u32 v136, v129, 8, v136
  v_add_u32 v58, s83, v136
  v_mul_u32_u24 v137, 120, v131
  v_add3_u32 v59, v58, v137, 8
  v_lshlrev_b32 v136, 8, v129
  v_lshl_add_u32 v136, v128, 2, v136
  v_add_u32 v136, 2048, v136
  v_add_u32 v60, s83, v136
  s_cmp_ge_u32 s34, 2
  s_cbranch_scc1 L_e3
  s_cmp_eq_u32 s34, 1
  s_cbranch_scc1 L_e2
  v_lshl_add_u32 v136, v131, 4, v128
  v_mov_b32 v137, v133
  v_sub_u32 v138, 6, v131
  v_lshlrev_b32 v138, v138, v136
  v_lshl_add_u32 v138, v131, 9, v138
  s_branch L_e
L_e2:
  v_add_u32 v136, 32, v130
  v_mov_b32 v137, v131
  v_lshlrev_b32 v138, 4, v136
  v_add_u32 v138, 1024, v138
  s_branch L_e
L_e3:
  v_add_u32 v136, 64, v1
  v_mov_b32 v137, s12
  v_lshlrev_b32 v138, 3, v136
  v_add_u32 v138, 1536, v138
L_e:
  v_mul_u32_u24 v139, 6144, v137
  v_add_u32 v138, v138, v139
  v_add_u32 v243, 149760, v138
  v_mul_u32_u24 v137, 8320, v137
  v_lshlrev_b32 v136, 5, v136
  v_sub_u32 v137, v137, v136
  v_add_u32 v126, 4064, v137
  v_mul_u32_u24 v136, 4608, v131
  v_lshl_add_u32 v136, v130, 4, v136
  v_add_u32 v127, 16640, v136
  s_mov_b64 s[16:17], s[24:25]
  s_mov_b32 s18, 0x00158000
  s_mov_b32 s19, 0x20000
  s_mov_b64 s[56:57], s[32:33]
  s_mov_b32 s58, 0x10000000
  s_mov_b32 s59, 0x20000
  s_mov_b64 s[52:53], s[32:33]
  s_mov_b32 s54, 0x00560000
  s_mov_b32 s55, 0x20000
  s_mov_b64 s[60:61], s[28:29]
  s_mov_b32 s62, 0x00200000
  s_mov_b32 s63, 0x20000
  v_bfe_u32 v136, v1, 1, 3
  v_xor_b32 v136, v136, v131
  v_lshlrev_b32 v136, 4, v136
  v_lshl_add_u32 v136, v130, 7, v136
  s_lshl_b32 s82, s11, 13
  s_add_u32 s82, s82, 67328
  v_add_u32 v17, s82, v136
  v_xor_b32 v18, 32, v17
  v_xor_b32 v19, 64, v17
  v_xor_b32 v20, 96, v17
  v_lshl_add_u32 v136, v131, 3, v134
  v_mul_u32_u24 v136, 192, v136
  v_lshl_add_u32 v136, v132, 3, v136
  s_mul_i32 s82, s12, 96
  s_add_u32 s82, s82, 83712
  v_add_u32 v136, s82, v136
  v_lshl_add_u32 v21, v133, 5, v136
  v_mul_u32_u24 v137, 12320, v133
  v_add3_u32 v22, v136, v137, 64
  v_bfe_u32 v137, v1, 1, 1
  v_lshl_add_u32 v136, v129, 1, v137
  v_lshl_add_u32 v136, v136, 3, v134
  v_lshlrev_b32 v136, 7, v136
  v_bfe_u32 v138, v1, 3, 1
  v_lshl_add_u32 v137, v137, 2, v138
  v_lshl_add_u32 v136, v137, 4, v136
  v_and_b32 v137, 1, v1
  v_lshl_add_u32 v136, v137, 3, v136
  s_lshl_b32 s82, s34, 5
  v_xor_b32 v136, s82, v136
  s_cbranch_vccnz L_sk0
  s_add_u32 m0, s75, s74
  s_nop 0
  buffer_load_dwordx4 v5, s[48:51], s65 offen lds
L_sk0:
  s_lshr_b32 s84, s36, 3
  s_lshl_b32 s82, s84, 13
  s_add_u32 s82, s82, 67328
  v_add_u32 v62, s82, v136
  v_xor_b32 v63, 32, v62
  v_xor_b32 v64, 16, v62
  v_xor_b32 v65, 48, v62
  s_lshl_b32 s82, s79, 1
  s_add_u32 s82, s82, s84
  s_lshl_b32 s82, s82, 4
  s_add_u32 s82, s82, s35
  s_lshl_b32 s82, s82, 2
  s_add_u32 s82, s82, 0x00a40000
  v_mov_b32 v29, s82
  s_lshl_b32 s82, s79, 2
  s_add_u32 s82, s82, s34
  s_lshl_b32 s82, s82, 16
  s_lshl_b32 s83, s35, 8
  s_add_u32 s82, s82, s83
  s_add_u32 s82, s82, 0x00600000
  s_lshl_b32 s83, s84, 7
  s_add_u32 s82, s82, s83
  v_and_b32 v136, 7, v1
  v_lshlrev_b32 v136, 12, v136
  v_lshrrev_b32 v137, 3, v1
  v_lshl_add_u32 v136, v137, 4, v136
  v_add_u32 v68, s82, v136
  s_mul_i32 s82, s34, 360448
  s_lshl_b32 s83, s38, 7
  s_add_u32 s82, s82, s83
  v_lshrrev_b32 v136, 3, v1
  v_and_b32 v137, 7, v1
  v_lshlrev_b32 v138, 2, v133
  v_xor_b32 v137, v137, v138
  v_lshlrev_b32 v136, 10, v136
  v_lshl_add_u32 v136, v137, 4, v136
  v_add_u32 v122, s82, v136
  v_add_u32 v123, 7168, v122
  v_add_u32 v124, 14336, v122
  v_add_u32 v125, 21504, v122
  v_lshl_add_u32 v136, v131, 2, v134
  v_lshlrev_b32 v136, 7, v136
  v_bfe_u32 v137, v1, 3, 1
  v_lshlrev_b32 v137, 2, v137
  v_lshl_add_u32 v137, v133, 1, v137
  v_bfe_u32 v138, v1, 1, 1
  v_add_u32 v137, v137, v138
  v_lshl_add_u32 v136, v137, 4, v136
  s_cbranch_vccnz L_sk1
  buffer_load_dwordx4 v6, s[48:51], s65 offen offset:1024 lds
L_sk1:
  v_and_b32 v137, 1, v1
  v_lshl_add_u32 v136, v137, 3, v136
  s_lshl_b32 s82, s12, 6
  v_xor_b32 v136, s82, v136
  v_add_u32 v224, s95, v136
  v_add_u32 v224, 26112, v224
  v_xor_b32 v225, 64, v224
  v_add_u32 v226, 82432, v224
  v_add_u32 v227, 82432, v225
  s_mul_i32 s82, s36, 6
  s_mul_i32 s83, s12, 3
  s_add_u32 s82, s82, s83
  s_lshl_b32 s82, s82, 6
  s_lshl_b32 s83, s35, 2
  s_add_u32 s82, s82, s83
  s_and_b32 s83, s34, 2
  s_add_u32 s82, s82, s83
  s_lshl_b32 s82, s82, 10
  v_add_u32 v228, s82, v135
  v_add_u32 v229, 0x10000, v228
  v_add_u32 v230, 0x20000, v228
  s_lshl_b32 s83, s12, 8
  s_mul_i32 s82, s11, 8320
  s_sub_u32 s82, s82, s83
  s_add_u32 s82, s82, 3360
  v_add_u32 v136, 1, v128
  v_lshrrev_b32 v136, 1, v136
  v_lshlrev_b32 v136, 2, v136
  v_lshlrev_b32 v137, 4, v129
  v_sub_u32 v136, v137, v136
  v_and_b32 v138, 1, v1
  v_xor_b32 v138, 1, v138
  v_mul_u32_u24 v138, 4160, v138
  v_add3_u32 v231, v136, v138, s82
  v_subrev_u32 v232, 1024, v231
  v_subrev_u32 v233, 2048, v231
  v_subrev_u32 v234, 3072, v231
  s_mul_i32 s82, s11, 4608
  s_sub_u32 s82, s82, s83
  s_add_u32 s82, s82, 16928
  v_lshl_add_u32 v235, v128, 5, v137
  v_add_u32 v235, s82, v235
  s_lshl_b32 s94, s2, 13
  s_lshl_b32 s82, s34, 11
  s_add_u32 s93, s94, s82
  s_add_u32 s93, s93, 0x00c00000
  s_add_u32 s94, s94, 0x00600000
  v_lshlrev_b32 v136, 3, v129
  s_cbranch_vccnz L_sk2
  buffer_load_dwordx4 v7, s[48:51], s65 offen offset:2048 lds
  s_add_u32 s64, s64, s66
  s_sub_u32 s67, s64, s101
  s_min_u32 s64, s64, s67
  s_add_u32 s65, s65, s68
  s_sub_u32 s67, s65, s69
  s_min_u32 s65, s65, s67
  s_mov_b32 s75, 108544
L_sk2:
  v_lshl_add_u32 v238, v128, 5, v136
  v_lshlrev_b32 v136, 4, v0
  v_add_u32 v252, 17152, v136
  s_lshl_b32 s82, s35, 1
  s_add_u32 s82, s82, s11
  s_lshl_b32 s82, s82, 4
  s_add_u32 s82, s82, s36
  s_lshl_b32 s82, s82, 1
  s_add_u32 s82, s82, s12
  s_lshl_b32 s82, s82, 2
  s_add_u32 s82, s82, 0x00a10000
  v_mov_b32 v236, s82
  s_lshr_b32 s82, s2, 5
  s_lshl_b32 s82, s82, 7
  s_add_u32 s82, s82, 0x00a40000
  v_lshl_add_u32 v24, v130, 2, s82
  s_mov_b32 s92, 0
  s_mov_b32 s86, 0xbdd2d3e8
  s_mov_b32 s87, 0xbdd2d3e8
  s_mov_b32 s78, 0
  s_mov_b32 s96, 41216
  s_mov_b32 s97, 0xfffebe00
  s_mov_b32 s71, 41216
  s_mov_b32 s70, 41216
  s_cmp_eq_u32 s34, 0
  s_cselect_b32 s76, 4, -1
  s_waitcnt vmcnt(10)
  v_readfirstlane_b32 s77, v78
  s_add_u32 s77, s77, 1
  s_mov_b32 m0, s13
  v_lshlrev_b32 v72, 16, v72
  v_lshlrev_b32 v76, 16, v76
  v_lshlrev_b32 v73, 16, v73
  v_lshlrev_b32 v74, 16, v74
  v_lshlrev_b32 v75, 16, v75
  v_lshlrev_b32 v254, 16, v77
  v_mul_f32 v72, 0x3fb8aa3b, v72
  v_mul_f32 v76, 0x3fb8aa3b, v76
  v_mov_b32 v48, 0x3f80
  v_exp_f32 v72, v72
  v_exp_f32 v76, v76
  ds_write_addtid_b32 v48 offset:11808
  v_cvt_pk_bf16_f32 v46, v72, v76
  v_lshlrev_b32 v72, 16, v46
  v_and_b32 v76, 0xffff0000, v46
  v_mul_f32 v80, v72, v76
  v_mul_f32 v81, v73, v76
  v_add_f32 v47, v76, v76
  v_mul_f32 v80, 0xbfb8aa3b, v80
  v_mul_f32 v81, 0.15915494, v81
  v_mul_f32 v82, v74, v47
  v_mul_f32 v83, v75, v47
  v_mul_f32 v50, 0x41000000, v80
  v_mul_f32 v51, 0x41000000, v81
  v_mul_f32 v52, 0x43000000, v80
  v_exp_f32 v50, v50
  v_fract_f32 v51, v51
  v_mul_f32 v53, 0x43000000, v81
  v_exp_f32 v52, v52
  v_cos_f32 v98, v51
  v_sin_f32 v99, v51
  v_fract_f32 v53, v53
  v_fract_f32 v55, v81
  v_pk_mul_f32 v[98:99], v[98:99], v[50:51] op_sel_hi:[1,0]
  v_cos_f32 v100, v53
  v_sin_f32 v101, v53
  v_exp_f32 v54, v80
  v_cos_f32 v84, v55
  v_pk_mul_f32 v[100:101], v[100:101], v[52:53] op_sel_hi:[1,0]
  v_sin_f32 v85, v55
  v_cvt_pk_bf16_f32 v40, v98, v99
  v_cvt_pk_bf16_f32 v41, v82, -v83
  v_pk_mul_f32 v[84:85], v[84:85], v[54:55] op_sel_hi:[1,0]
  ds_write_addtid_b32 v40 offset:12096
  ds_write_addtid_b32 v41 offset:0
  v_pk_mul_f32 v[108:109], v[82:83], v[100:101] op_sel:[0,0] op_sel_hi:[0,1]
  v_pk_mul_f32 v[102:103], v[98:99], v[98:99] op_sel:[0,0] op_sel_hi:[0,1]
  v_pk_mul_f32 v[86:87], v[84:85], v[84:85] op_sel:[0,0] op_sel_hi:[0,1]
  v_pk_fma_f32 v[108:109], v[82:83], v[100:101], v[108:109] op_sel:[1,1,0] op_sel_hi:[1,0,1] neg_lo:[1,0,0]
  v_pk_fma_f32 v[102:103], v[98:99], v[98:99], v[102:103] op_sel:[1,1,0] op_sel_hi:[1,0,1] neg_lo:[1,0,0]
  v_pk_fma_f32 v[86:87], v[84:85], v[84:85], v[86:87] op_sel:[1,1,0] op_sel_hi:[1,0,1] neg_lo:[1,0,0]
  v_cvt_pk_bf16_f32 v42, v108, -v109
  v_pk_mul_f32 v[110:111], v[108:109], v[100:101] op_sel:[0,0] op_sel_hi:[0,1]
  v_cvt_pk_bf16_f32 v44, v102, v103
  ds_write_addtid_b32 v42 offset:2304
  v_pk_fma_f32 v[110:111], v[108:109], v[100:101], v[110:111] op_sel:[1,1,0] op_sel_hi:[1,0,1] neg_lo:[1,0,0]
  v_pk_mul_f32 v[104:105], v[102:103], v[98:99] op_sel:[0,0] op_sel_hi:[0,1]
  v_pk_mul_f32 v[88:89], v[86:87], v[84:85] op_sel:[0,0] op_sel_hi:[0,1]
  v_cvt_pk_bf16_f32 v43, v110, -v111
  v_pk_mul_f32 v[112:113], v[110:111], v[100:101] op_sel:[0,0] op_sel_hi:[0,1]
  v_pk_fma_f32 v[104:105], v[102:103], v[98:99], v[104:105] op_sel:[1,1,0] op_sel_hi:[1,0,1] neg_lo:[1,0,0]
  ds_write_addtid_b32 v43 offset:4608
  ds_write_addtid_b32 v44 offset:12384
  v_pk_fma_f32 v[112:113], v[110:111], v[100:101], v[112:113] op_sel:[1,1,0] op_sel_hi:[1,0,1] neg_lo:[1,0,0]
  v_cvt_pk_bf16_f32 v40, v104, v105
  v_pk_fma_f32 v[88:89], v[86:87], v[84:85], v[88:89] op_sel:[1,1,0] op_sel_hi:[1,0,1] neg_lo:[1,0,0]
  v_cvt_pk_bf16_f32 v45, v112, -v113
  v_pk_mul_f32 v[114:115], v[112:113], v[100:101] op_sel:[0,0] op_sel_hi:[0,1]
  v_pk_mul_f32 v[102:103], v[104:105], v[98:99] op_sel:[0,0] op_sel_hi:[0,1]
  ds_write_addtid_b32 v45 offset:5760
  ds_write_addtid_b32 v40 offset:12672
  v_pk_fma_f32 v[114:115], v[112:113], v[100:101], v[114:115] op_sel:[1,1,0] op_sel_hi:[1,0,1] neg_lo:[1,0,0]
  v_pk_fma_f32 v[102:103], v[104:105], v[98:99], v[102:103] op_sel:[1,1,0] op_sel_hi:[1,0,1] neg_lo:[1,0,0]
  v_pk_mul_f32 v[90:91], v[88:89], v[84:85] op_sel:[0,0] op_sel_hi:[0,1]
  v_cvt_pk_bf16_f32 v41, v114, -v115
  v_cvt_pk_bf16_f32 v42, v102, v103
  v_pk_fma_f32 v[90:91], v[88:89], v[84:85], v[90:91] op_sel:[1,1,0] op_sel_hi:[1,0,1] neg_lo:[1,0,0]
  ds_write_addtid_b32 v41 offset:6912
  ds_write_addtid_b32 v42 offset:12960
  v_pk_mul_f32 v[116:117], v[114:115], v[100:101] op_sel:[0,0] op_sel_hi:[0,1]
  v_pk_mul_f32 v[104:105], v[102:103], v[98:99] op_sel:[0,0] op_sel_hi:[0,1]
  v_pk_mul_f32 v[92:93], v[90:91], v[84:85] op_sel:[0,0] op_sel_hi:[0,1]
  v_pk_fma_f32 v[116:117], v[114:115], v[100:101], v[116:117] op_sel:[1,1,0] op_sel_hi:[1,0,1] neg_lo:[1,0,0]
  v_pk_fma_f32 v[104:105], v[102:103], v[98:99], v[104:105] op_sel:[1,1,0] op_sel_hi:[1,0,1] neg_lo:[1,0,0]
  v_pk_fma_f32 v[92:93], v[90:91], v[84:85], v[92:93] op_sel:[1,1,0] op_sel_hi:[1,0,1] neg_lo:[1,0,0]
  v_cvt_pk_bf16_f32 v43, v116, -v117
  v_cvt_pk_bf16_f32 v44, v104, v105
  v_pk_mul_f32 v[118:119], v[116:117], v[100:101] op_sel:[0,0] op_sel_hi:[0,1]
  ds_write_addtid_b32 v43 offset:7488
  ds_write_addtid_b32 v44 offset:13248
  v_pk_fma_f32 v[118:119], v[116:117], v[100:101], v[118:119] op_sel:[1,1,0] op_sel_hi:[1,0,1] neg_lo:[1,0,0]
  v_pk_mul_f32 v[102:103], v[104:105], v[98:99] op_sel:[0,0] op_sel_hi:[0,1]
  v_pk_mul_f32 v[94:95], v[92:93], v[84:85] op_sel:[0,0] op_sel_hi:[0,1]
  v_cvt_pk_bf16_f32 v45, v118, -v119
  v_pk_fma_f32 v[102:103], v[104:105], v[98:99], v[102:103] op_sel:[1,1,0] op_sel_hi:[1,0,1] neg_lo:[1,0,0]
  v_pk_fma_f32 v[94:95], v[92:93], v[84:85], v[94:95] op_sel:[1,1,0] op_sel_hi:[1,0,1] neg_lo:[1,0,0]
  ds_write_addtid_b32 v45 offset:8064
  v_cvt_pk_bf16_f32 v40, v102, v103
  v_pk_mul_f32 v[120:121], v[118:119], v[100:101] op_sel:[0,0] op_sel_hi:[0,1]
  v_pk_mul_f32 v[104:105], v[102:103], v[98:99] op_sel:[0,0] op_sel_hi:[0,1]
  ds_write_addtid_b32 v40 offset:13536
  v_pk_fma_f32 v[120:121], v[118:119], v[100:101], v[120:121] op_sel:[1,1,0] op_sel_hi:[1,0,1] neg_lo:[1,0,0]
  v_pk_fma_f32 v[104:105], v[102:103], v[98:99], v[104:105] op_sel:[1,1,0] op_sel_hi:[1,0,1] neg_lo:[1,0,0]
  v_pk_mul_f32 v[96:97], v[94:95], v[84:85] op_sel:[0,0] op_sel_hi:[0,1]
  v_cvt_pk_bf16_f32 v41, v120, -v121
  v_cvt_pk_bf16_f32 v42, v104, v105
  v_pk_fma_f32 v[96:97], v[94:95], v[84:85], v[96:97] op_sel:[1,1,0] op_sel_hi:[1,0,1] neg_lo:[1,0,0]
  ds_write_addtid_b32 v41 offset:8640
  ds_write_addtid_b32 v42 offset:13824
  v_pk_mul_f32 v[50:51], v[120:121], v[100:101] op_sel:[0,0] op_sel_hi:[0,1]
  v_pk_mul_f32 v[102:103], v[104:105], v[98:99] op_sel:[0,0] op_sel_hi:[0,1]
  v_pk_mul_f32 v[32:33], v[82:83], v[84:85] op_sel:[0,0] op_sel_hi:[0,1]
  v_pk_fma_f32 v[50:51], v[120:121], v[100:101], v[50:51] op_sel:[1,1,0] op_sel_hi:[1,0,1] neg_lo:[1,0,0]
  v_pk_fma_f32 v[102:103], v[104:105], v[98:99], v[102:103] op_sel:[1,1,0] op_sel_hi:[1,0,1] neg_lo:[1,0,0]
  v_pk_fma_f32 v[32:33], v[82:83], v[84:85], v[32:33] op_sel:[1,1,0] op_sel_hi:[1,0,1] neg_lo:[1,0,0]
  v_cvt_pk_bf16_f32 v43, v50, -v51
  v_cvt_pk_bf16_f32 v44, v102, v103
  v_pk_mul_f32 v[52:53], v[50:51], v[100:101] op_sel:[0,0] op_sel_hi:[0,1]
  ds_write_addtid_b32 v43 offset:9216
  ds_write_addtid_b32 v44 offset:14112
  v_pk_fma_f32 v[52:53], v[50:51], v[100:101], v[52:53] op_sel:[1,1,0] op_sel_hi:[1,0,1] neg_lo:[1,0,0]
  v_pk_mul_f32 v[104:105], v[102:103], v[98:99] op_sel:[0,0] op_sel_hi:[0,1]
  v_pk_mul_f32 v[34:35], v[82:83], v[86:87] op_sel:[0,0] op_sel_hi:[0,1]
  v_cvt_pk_bf16_f32 v45, v52, -v53
  v_pk_fma_f32 v[104:105], v[102:103], v[98:99], v[104:105] op_sel:[1,1,0] op_sel_hi:[1,0,1] neg_lo:[1,0,0]
  v_pk_mul_f32 v[50:51], v[52:53], v[100:101] op_sel:[0,0] op_sel_hi:[0,1]
  ds_write_addtid_b32 v45 offset:9504
  v_cvt_pk_bf16_f32 v40, v104, v105
  v_pk_fma_f32 v[50:51], v[52:53], v[100:101], v[50:51] op_sel:[1,1,0] op_sel_hi:[1,0,1] neg_lo:[1,0,0]
  v_pk_mul_f32 v[102:103], v[104:105], v[98:99] op_sel:[0,0] op_sel_hi:[0,1]
  ds_write_addtid_b32 v40 offset:14400
  v_cvt_pk_bf16_f32 v41, v50, -v51
  v_pk_fma_f32 v[102:103], v[104:105], v[98:99], v[102:103] op_sel:[1,1,0] op_sel_hi:[1,0,1] neg_lo:[1,0,0]
  v_pk_mul_f32 v[52:53], v[50:51], v[100:101] op_sel:[0,0] op_sel_hi:[0,1]
  ds_write_addtid_b32 v41 offset:9792
  v_cvt_pk_bf16_f32 v42, v102, v103
  v_pk_fma_f32 v[52:53], v[50:51], v[100:101], v[52:53] op_sel:[1,1,0] op_sel_hi:[1,0,1] neg_lo:[1,0,0]
  v_pk_mul_f32 v[104:105], v[102:103], v[98:99] op_sel:[0,0] op_sel_hi:[0,1]
  ds_write_addtid_b32 v42 offset:14688
  v_cvt_pk_bf16_f32 v43, v52, -v53
  v_pk_fma_f32 v[104:105], v[102:103], v[98:99], v[104:105] op_sel:[1,1,0] op_sel_hi:[1,0,1] neg_lo:[1,0,0]
  v_pk_mul_f32 v[50:51], v[52:53], v[100:101] op_sel:[0,0] op_sel_hi:[0,1]
  ds_write_addtid_b32 v43 offset:10080
  v_cvt_pk_bf16_f32 v44, v104, v105
  v_pk_fma_f32 v[50:51], v[52:53], v[100:101], v[50:51] op_sel:[1,1,0] op_sel_hi:[1,0,1] neg_lo:[1,0,0]
  v_pk_mul_f32 v[102:103], v[104:105], v[98:99] op_sel:[0,0] op_sel_hi:[0,1]
  ds_write_addtid_b32 v44 offset:14976
  v_cvt_pk_bf16_f32 v45, v50, -v51
  v_pk_fma_f32 v[102:103], v[104:105], v[98:99], v[102:103] op_sel:[1,1,0] op_sel_hi:[1,0,1] neg_lo:[1,0,0]
  v_pk_mul_f32 v[52:53], v[50:51], v[100:101] op_sel:[0,0] op_sel_hi:[0,1]
  ds_write_addtid_b32 v45 offset:10368
  v_cvt_pk_bf16_f32 v40, v102, v103
  v_pk_fma_f32 v[52:53], v[50:51], v[100:101], v[52:53] op_sel:[1,1,0] op_sel_hi:[1,0,1] neg_lo:[1,0,0]
  v_pk_mul_f32 v[104:105], v[102:103], v[98:99] op_sel:[0,0] op_sel_hi:[0,1]
  ds_write_addtid_b32 v40 offset:15264
  v_cvt_pk_bf16_f32 v41, v52, -v53
  v_pk_fma_f32 v[104:105], v[102:103], v[98:99], v[104:105] op_sel:[1,1,0] op_sel_hi:[1,0,1] neg_lo:[1,0,0]
  v_pk_mul_f32 v[50:51], v[52:53], v[100:101] op_sel:[0,0] op_sel_hi:[0,1]
  ds_write_addtid_b32 v41 offset:10656
  v_cvt_pk_bf16_f32 v42, v104, v105
  v_pk_fma_f32 v[50:51], v[52:53], v[100:101], v[50:51] op_sel:[1,1,0] op_sel_hi:[1,0,1] neg_lo:[1,0,0]
  v_pk_mul_f32 v[102:103], v[104:105], v[98:99] op_sel:[0,0] op_sel_hi:[0,1]
  ds_write_addtid_b32 v42 offset:15552
  v_cvt_pk_bf16_f32 v43, v50, -v51
  v_pk_fma_f32 v[102:103], v[104:105], v[98:99], v[102:103] op_sel:[1,1,0] op_sel_hi:[1,0,1] neg_lo:[1,0,0]
  v_pk_mul_f32 v[52:53], v[50:51], v[100:101] op_sel:[0,0] op_sel_hi:[0,1]
  ds_write_addtid_b32 v43 offset:10944
  v_cvt_pk_bf16_f32 v44, v102, v103
  v_pk_fma_f32 v[52:53], v[50:51], v[100:101], v[52:53] op_sel:[1,1,0] op_sel_hi:[1,0,1] neg_lo:[1,0,0]
  v_pk_mul_f32 v[104:105], v[102:103], v[98:99] op_sel:[0,0] op_sel_hi:[0,1]
  ds_write_addtid_b32 v44 offset:15840
  v_cvt_pk_bf16_f32 v45, v52, -v53
  v_pk_fma_f32 v[104:105], v[102:103], v[98:99], v[104:105] op_sel:[1,1,0] op_sel_hi:[1,0,1] neg_lo:[1,0,0]
  v_pk_mul_f32 v[50:51], v[52:53], v[100:101] op_sel:[0,0] op_sel_hi:[0,1]
  ds_write_addtid_b32 v45 offset:11232
  v_cvt_pk_bf16_f32 v40, v104, v105
  v_pk_fma_f32 v[50:51], v[52:53], v[100:101], v[50:51] op_sel:[1,1,0] op_sel_hi:[1,0,1] neg_lo:[1,0,0]
  v_cvt_pk_bf16_f32 v42, v32, -v33
  ds_write_addtid_b32 v40 offset:16128
  v_cvt_pk_bf16_f32 v41, v50, -v51
  v_pk_fma_f32 v[34:35], v[82:83], v[86:87], v[34:35] op_sel:[1,1,0] op_sel_hi:[1,0,1] neg_lo:[1,0,0]
  v_pk_mul_f32 v[36:37], v[82:83], v[88:89] op_sel:[0,0] op_sel_hi:[0,1]
  ds_write_addtid_b32 v41 offset:11520
  ds_write_addtid_b32 v42 offset:288
  v_cvt_pk_bf16_f32 v43, v34, -v35
  v_pk_fma_f32 v[36:37], v[82:83], v[88:89], v[36:37] op_sel:[1,1,0] op_sel_hi:[1,0,1] neg_lo:[1,0,0]
  v_pk_mul_f32 v[38:39], v[82:83], v[90:91] op_sel:[0,0] op_sel_hi:[0,1]
  ds_write_addtid_b32 v43 offset:576
  v_cvt_pk_bf16_f32 v44, v36, -v37
  v_pk_fma_f32 v[38:39], v[82:83], v[90:91], v[38:39] op_sel:[1,1,0] op_sel_hi:[1,0,1] neg_lo:[1,0,0]
  v_pk_mul_f32 v[32:33], v[82:83], v[92:93] op_sel:[0,0] op_sel_hi:[0,1]
  ds_write_addtid_b32 v44 offset:864
  v_cvt_pk_bf16_f32 v45, v38, -v39
  v_pk_fma_f32 v[32:33], v[82:83], v[92:93], v[32:33] op_sel:[1,1,0] op_sel_hi:[1,0,1] neg_lo:[1,0,0]
  v_pk_mul_f32 v[34:35], v[82:83], v[94:95] op_sel:[0,0] op_sel_hi:[0,1]
  ds_write_addtid_b32 v45 offset:1152
  v_cvt_pk_bf16_f32 v40, v32, -v33
  v_pk_fma_f32 v[34:35], v[82:83], v[94:95], v[34:35] op_sel:[1,1,0] op_sel_hi:[1,0,1] neg_lo:[1,0,0]
  v_pk_mul_f32 v[36:37], v[82:83], v[96:97] op_sel:[0,0] op_sel_hi:[0,1]
  ds_write_addtid_b32 v40 offset:1440
  v_cvt_pk_bf16_f32 v41, v34, -v35
  v_pk_fma_f32 v[36:37], v[82:83], v[96:97], v[36:37] op_sel:[1,1,0] op_sel_hi:[1,0,1] neg_lo:[1,0,0]
  v_pk_mul_f32 v[38:39], v[108:109], v[84:85] op_sel:[0,0] op_sel_hi:[0,1]
  ds_write_addtid_b32 v41 offset:1728
  v_cvt_pk_bf16_f32 v42, v36, -v37
  v_pk_fma_f32 v[38:39], v[108:109], v[84:85], v[38:39] op_sel:[1,1,0] op_sel_hi:[1,0,1] neg_lo:[1,0,0]
  v_pk_mul_f32 v[32:33], v[108:109], v[86:87] op_sel:[0,0] op_sel_hi:[0,1]
  ds_write_addtid_b32 v42 offset:2016
  v_cvt_pk_bf16_f32 v43, v38, -v39
  v_pk_fma_f32 v[32:33], v[108:109], v[86:87], v[32:33] op_sel:[1,1,0] op_sel_hi:[1,0,1] neg_lo:[1,0,0]
  v_pk_mul_f32 v[34:35], v[108:109], v[88:89] op_sel:[0,0] op_sel_hi:[0,1]
  ds_write_addtid_b32 v43 offset:2592
  v_cvt_pk_bf16_f32 v44, v32, -v33
  v_pk_fma_f32 v[34:35], v[108:109], v[88:89], v[34:35] op_sel:[1,1,0] op_sel_hi:[1,0,1] neg_lo:[1,0,0]
  v_pk_mul_f32 v[36:37], v[108:109], v[90:91] op_sel:[0,0] op_sel_hi:[0,1]
  ds_write_addtid_b32 v44 offset:2880
  v_cvt_pk_bf16_f32 v45, v34, -v35
  v_pk_fma_f32 v[36:37], v[108:109], v[90:91], v[36:37] op_sel:[1,1,0] op_sel_hi:[1,0,1] neg_lo:[1,0,0]
  v_pk_mul_f32 v[38:39], v[108:109], v[92:93] op_sel:[0,0] op_sel_hi:[0,1]
  ds_write_addtid_b32 v45 offset:3168
  v_cvt_pk_bf16_f32 v40, v36, -v37
  v_pk_fma_f32 v[38:39], v[108:109], v[92:93], v[38:39] op_sel:[1,1,0] op_sel_hi:[1,0,1] neg_lo:[1,0,0]
  v_pk_mul_f32 v[32:33], v[108:109], v[94:95] op_sel:[0,0] op_sel_hi:[0,1]
  ds_write_addtid_b32 v40 offset:3456
  v_cvt_pk_bf16_f32 v41, v38, -v39
  v_pk_fma_f32 v[32:33], v[108:109], v[94:95], v[32:33] op_sel:[1,1,0] op_sel_hi:[1,0,1] neg_lo:[1,0,0]
  v_pk_mul_f32 v[34:35], v[108:109], v[96:97] op_sel:[0,0] op_sel_hi:[0,1]
  ds_write_addtid_b32 v41 offset:3744
  v_cvt_pk_bf16_f32 v42, v32, -v33
  v_pk_fma_f32 v[34:35], v[108:109], v[96:97], v[34:35] op_sel:[1,1,0] op_sel_hi:[1,0,1] neg_lo:[1,0,0]
  v_pk_mul_f32 v[36:37], v[110:111], v[86:87] op_sel:[0,0] op_sel_hi:[0,1]
  ds_write_addtid_b32 v42 offset:4032
  v_cvt_pk_bf16_f32 v43, v34, -v35
  v_pk_fma_f32 v[36:37], v[110:111], v[86:87], v[36:37] op_sel:[1,1,0] op_sel_hi:[1,0,1] neg_lo:[1,0,0]
  v_pk_mul_f32 v[38:39], v[110:111], v[90:91] op_sel:[0,0] op_sel_hi:[0,1]
  ds_write_addtid_b32 v43 offset:4320
  v_cvt_pk_bf16_f32 v44, v36, -v37
  v_pk_fma_f32 v[38:39], v[110:111], v[90:91], v[38:39] op_sel:[1,1,0] op_sel_hi:[1,0,1] neg_lo:[1,0,0]
  v_pk_mul_f32 v[32:33], v[110:111], v[94:95] op_sel:[0,0] op_sel_hi:[0,1]
  ds_write_addtid_b32 v44 offset:4896
  v_cvt_pk_bf16_f32 v45, v38, -v39
  v_pk_fma_f32 v[32:33], v[110:111], v[94:95], v[32:33] op_sel:[1,1,0] op_sel_hi:[1,0,1] neg_lo:[1,0,0]
  v_pk_mul_f32 v[34:35], v[112:113], v[86:87] op_sel:[0,0] op_sel_hi:[0,1]
  ds_write_addtid_b32 v45 offset:5184
  v_cvt_pk_bf16_f32 v40, v32, -v33
  v_pk_fma_f32 v[34:35], v[112:113], v[86:87], v[34:35] op_sel:[1,1,0] op_sel_hi:[1,0,1] neg_lo:[1,0,0]
  v_pk_mul_f32 v[36:37], v[112:113], v[90:91] op_sel:[0,0] op_sel_hi:[0,1]
  ds_write_addtid_b32 v40 offset:5472
  v_cvt_pk_bf16_f32 v41, v34, -v35
  v_pk_fma_f32 v[36:37], v[112:113], v[90:91], v[36:37] op_sel:[1,1,0] op_sel_hi:[1,0,1] neg_lo:[1,0,0]
  v_pk_mul_f32 v[38:39], v[112:113], v[94:95] op_sel:[0,0] op_sel_hi:[0,1]
  ds_write_addtid_b32 v41 offset:6048
  v_cvt_pk_bf16_f32 v42, v36, -v37
  v_pk_fma_f32 v[38:39], v[112:113], v[94:95], v[38:39] op_sel:[1,1,0] op_sel_hi:[1,0,1] neg_lo:[1,0,0]
  v_pk_mul_f32 v[32:33], v[114:115], v[90:91] op_sel:[0,0] op_sel_hi:[0,1]
  ds_write_addtid_b32 v42 offset:6336
  v_cvt_pk_bf16_f32 v43, v38, -v39
  v_pk_fma_f32 v[32:33], v[114:115], v[90:91], v[32:33] op_sel:[1,1,0] op_sel_hi:[1,0,1] neg_lo:[1,0,0]
  v_pk_mul_f32 v[34:35], v[116:117], v[90:91] op_sel:[0,0] op_sel_hi:[0,1]
  ds_write_addtid_b32 v43 offset:6624
  v_cvt_pk_bf16_f32 v44, v32, -v33
  v_pk_fma_f32 v[34:35], v[116:117], v[90:91], v[34:35] op_sel:[1,1,0] op_sel_hi:[1,0,1] neg_lo:[1,0,0]
  v_pk_mul_f32 v[36:37], v[118:119], v[90:91] op_sel:[0,0] op_sel_hi:[0,1]
  ds_write_addtid_b32 v44 offset:7200
  v_cvt_pk_bf16_f32 v45, v34, -v35
  v_pk_fma_f32 v[36:37], v[118:119], v[90:91], v[36:37] op_sel:[1,1,0] op_sel_hi:[1,0,1] neg_lo:[1,0,0]
  v_pk_mul_f32 v[38:39], v[120:121], v[90:91] op_sel:[0,0] op_sel_hi:[0,1]
  ds_write_addtid_b32 v45 offset:7776
  v_cvt_pk_bf16_f32 v40, v36, -v37
  v_pk_fma_f32 v[38:39], v[120:121], v[90:91], v[38:39] op_sel:[1,1,0] op_sel_hi:[1,0,1] neg_lo:[1,0,0]
  ds_write_addtid_b32 v40 offset:8352
  v_cvt_pk_bf16_f32 v41, v38, -v39
  ds_write_addtid_b32 v41 offset:8928
  s_waitcnt lgkmcnt(0)
  ds_read_b128 a[0:3], v56 offset:11808
  ds_read_b128 a[4:7], v56 offset:0
  ds_read_b128 a[8:11], v56 offset:4608
  ds_read_b128 a[12:15], v56 offset:9216
  ds_read_b128 a[16:19], v56 offset:11872
  ds_read_b128 a[20:23], v56 offset:64
  ds_read_b128 a[24:27], v56 offset:4672
  ds_read_b128 a[28:31], v56 offset:9280
  ds_read_b128 a[32:35], v56 offset:11936
  ds_read_b128 a[36:39], v56 offset:128
  ds_read_b128 a[40:43], v56 offset:4736
  ds_read_b128 a[44:47], v56 offset:9344
  ds_read_b128 a[48:51], v56 offset:12000
  ds_read_b128 a[52:55], v56 offset:192
  ds_read_b128 a[56:59], v56 offset:4800
  ds_read_b128 a[60:63], v56 offset:9408
  v_and_b32 v2, 47, v1
  v_cmp_eq_u32 s[98:99], 0, v2
  v_mov_b32 v78, 0xc0135761
  v_mov_b32 v79, 0xc0135761
  v_cndmask_b32 v254, 0, v254, s[98:99]
  s_waitcnt lgkmcnt(12)
  v_mfma_f32_16x16x32_bf16 a[64:67], a[4:7], a[0:3], 0
  v_mfma_f32_16x16x32_bf16 a[68:71], a[8:11], a[0:3], 0
  v_mfma_f32_16x16x32_bf16 a[72:75], a[12:15], a[0:3], 0
  s_waitcnt lgkmcnt(8)
  v_mfma_f32_16x16x32_bf16 a[64:67], a[20:23], a[16:19], a[64:67]
  v_mfma_f32_16x16x32_bf16 a[68:71], a[24:27], a[16:19], a[68:71]
  v_mfma_f32_16x16x32_bf16 a[72:75], a[28:31], a[16:19], a[72:75]
  s_waitcnt lgkmcnt(4)
  v_mfma_f32_16x16x32_bf16 a[64:67], a[36:39], a[32:35], a[64:67]
  v_mfma_f32_16x16x32_bf16 a[68:71], a[40:43], a[32:35], a[68:71]
  v_mfma_f32_16x16x32_bf16 a[72:75], a[44:47], a[32:35], a[72:75]
  s_waitcnt lgkmcnt(0)
  v_mfma_f32_16x16x32_bf16 a[64:67], a[52:55], a[48:51], a[64:67]
  v_mfma_f32_16x16x32_bf16 a[68:71], a[56:59], a[48:51], a[68:71]
  v_mfma_f32_16x16x32_bf16 a[72:75], a[60:63], a[48:51], a[72:75]
  s_mov_b32 s39, 5
  s_nop 4
  ds_write_b128 v57, a[64:67]
  s_nop 0
  ds_write_b64 v58, a[68:69] offset:1024
  ds_write_b64 v59, a[70:71] offset:1024
  ds_write2_b32 v60, a72, a73 offset0:0 offset1:16
  ds_write2_b32 v60, a74, a75 offset0:32 offset1:48
  v_mov_b64 v[72:73], 0
  v_mov_b64 v[74:75], 0
  s_waitcnt lgkmcnt(0)
  s_barrier
  s_cbranch_vccnz L_expskip
L_exp:
  s_cmp_ge_u32 s34, 2
  s_cbranch_scc1 L_xr3
  s_cmp_eq_u32 s34, 1
  s_cbranch_scc1 L_xr2
  ds_read_b128 v[80:83], v243 offset:0
  ds_read_b128 v[32:35], v243 offset:3072
  ds_read_b128 v[84:87], v243 offset:16
  ds_read_b128 v[36:39], v243 offset:3088
  ds_read_b128 v[88:91], v243 offset:32
  ds_read_b128 v[40:43], v243 offset:3104
  ds_read_b128 v[92:95], v243 offset:48
  ds_read_b128 v[44:47], v243 offset:3120
  ds_read_b32 v96, v243 offset:64
  ds_read_b32 v48, v243 offset:3136
  s_branch L_xrd
L_xr2:
  ds_read_b128 v[80:83], v243 offset:0
  ds_read_b128 v[32:35], v243 offset:3072
  ds_read_b32 v84, v243 offset:16
  ds_read_b32 v36, v243 offset:3088
  s_branch L_xrd
L_xr3:
  ds_read_b64 v[80:81], v243 offset:0
  ds_read_b64 v[32:33], v243 offset:3072
  ds_read_b32 v82, v243 offset:8
  ds_read_b32 v34, v243 offset:3080
L_xrd:
  s_waitcnt lgkmcnt(0)
  v_cmp_gt_u32 s[98:99], 32, v1
  s_cmp_ge_u32 s34, 2
  s_cbranch_scc1 L_xv3
  s_cmp_eq_u32 s34, 1
  s_cbranch_scc1 L_xv2
  v_add_f32 v80, v254, v80
  v_pk_add_f32 v[80:81], v[80:81], v[32:33]
  v_pk_add_f32 v[82:83], v[82:83], v[34:35]
  v_pk_add_f32 v[84:85], v[84:85], v[36:37]
  v_pk_add_f32 v[86:87], v[86:87], v[38:39]
  v_pk_add_f32 v[88:89], v[88:89], v[40:41]
  v_pk_add_f32 v[90:91], v[90:91], v[42:43]
  v_pk_add_f32 v[92:93], v[92:93], v[44:45]
  v_pk_add_f32 v[94:95], v[94:95], v[46:47]
  v_add_f32 v96, v96, v48
  v_cndmask_b32 v96, v88, v96, s[98:99]
  v_cndmask_b32 v95, v88, v95, s[98:99]
  v_cndmask_b32 v94, v87, v94, s[98:99]
  v_cndmask_b32 v93, v86, v93, s[98:99]
  v_cndmask_b32 v92, v86, v92, s[98:99]
  v_cndmask_b32 v91, v86, v91, s[98:99]
  v_cndmask_b32 v90, v85, v90, s[98:99]
  v_cndmask_b32 v89, v84, v89, s[98:99]
  v_cndmask_b32 v88, v84, v88, s[98:99]
  v_cndmask_b32 v87, v84, v87, s[98:99]
  v_cndmask_b32 v86, v83, v86, s[98:99]
  v_cndmask_b32 v85, v82, v85, s[98:99]
  v_cndmask_b32 v84, v82, v84, s[98:99]
  v_cndmask_b32 v83, v82, v83, s[98:99]
  v_cndmask_b32 v82, v81, v82, s[98:99]
  v_cndmask_b32 v81, v80, v81, s[98:99]
  v_cvt_pk_bf16_f32 v104, v95, v94
  v_cvt_pk_bf16_f32 v105, v93, v92
  v_cvt_pk_bf16_f32 v106, v91, v90
  v_cvt_pk_bf16_f32 v107, v89, v88
  ds_write_b128 v126, v[104:107] offset:0
  v_cvt_pk_bf16_f32 v108, v87, v86
  v_cvt_pk_bf16_f32 v109, v85, v84
  v_cvt_pk_bf16_f32 v110, v83, v82
  v_cvt_pk_bf16_f32 v111, v81, v80
  ds_write_b128 v126, v[108:111] offset:16
  v_cvt_pk_bf16_f32 v112, v96, v95
  v_cvt_pk_bf16_f32 v113, v94, v93
  v_cvt_pk_bf16_f32 v114, v92, v91
  v_cvt_pk_bf16_f32 v115, v90, v89
  ds_write_b128 v126, v[112:115] offset:4160
  v_cvt_pk_bf16_f32 v116, v88, v87
  v_cvt_pk_bf16_f32 v117, v86, v85
  v_cvt_pk_bf16_f32 v118, v84, v83
  v_cvt_pk_bf16_f32 v119, v82, v81
  ds_write_b128 v126, v[116:119] offset:4176
  s_mov_b64 exec, 0x10001
  v_lshrrev_b32 v80, 16, v111
  v_mov_b32 v81, 0
  v_mov_b64 v[82:83], 0
  ds_write_b128 v126, v[72:75] offset:32
  ds_write_b128 v126, v[72:75] offset:48
  ds_write_b128 v126, v[80:83] offset:4192
  ds_write_b128 v126, v[72:75] offset:4208
  s_mov_b64 exec, -1
  s_branch L_xvd
L_xv2:
  v_pk_add_f32 v[80:81], v[80:81], v[32:33]
  v_pk_add_f32 v[82:83], v[82:83], v[34:35]
  v_add_f32 v84, v84, v36
  v_cvt_pk_bf16_f32 v104, v84, v84
  v_cvt_pk_bf16_f32 v105, v83, v83
  v_cvt_pk_bf16_f32 v106, v83, v82
  v_cvt_pk_bf16_f32 v107, v82, v82
  ds_write_b128 v126, v[104:107] offset:0
  v_cvt_pk_bf16_f32 v108, v82, v82
  v_cvt_pk_bf16_f32 v109, v81, v81
  v_cvt_pk_bf16_f32 v110, v81, v80
  v_cvt_pk_bf16_f32 v111, v80, v80
  ds_write_b128 v126, v[108:111] offset:16
  v_cvt_pk_bf16_f32 v112, v84, v84
  v_cvt_pk_bf16_f32 v113, v84, v83
  v_cvt_pk_bf16_f32 v114, v83, v83
  v_cvt_pk_bf16_f32 v115, v82, v82
  ds_write_b128 v126, v[112:115] offset:4160
  v_cvt_pk_bf16_f32 v116, v82, v82
  v_cvt_pk_bf16_f32 v117, v82, v81
  v_cvt_pk_bf16_f32 v118, v81, v81
  v_cvt_pk_bf16_f32 v119, v80, v80
  ds_write_b128 v126, v[116:119] offset:4176
  ds_write_b128 v127, v[72:75]
  s_branch L_xvd
L_xv3:
  v_pk_add_f32 v[80:81], v[80:81], v[32:33]
  v_add_f32 v82, v82, v34
  v_cvt_pk_bf16_f32 v104, v82, v82
  v_cvt_pk_bf16_f32 v105, v82, v82
  v_cvt_pk_bf16_f32 v106, v81, v81
  v_cvt_pk_bf16_f32 v107, v81, v81
  ds_write_b128 v126, v[104:107] offset:0
  v_cvt_pk_bf16_f32 v108, v81, v81
  v_cvt_pk_bf16_f32 v109, v81, v80
  v_cvt_pk_bf16_f32 v110, v80, v80
  v_cvt_pk_bf16_f32 v111, v80, v80
  ds_write_b128 v126, v[108:111] offset:16
  v_cvt_pk_bf16_f32 v112, v82, v82
  v_cvt_pk_bf16_f32 v113, v82, v82
  v_cvt_pk_bf16_f32 v114, v82, v81
  v_cvt_pk_bf16_f32 v115, v81, v81
  ds_write_b128 v126, v[112:115] offset:4160
  v_cvt_pk_bf16_f32 v116, v81, v81
  v_cvt_pk_bf16_f32 v117, v81, v81
  v_cvt_pk_bf16_f32 v118, v80, v80
  v_cvt_pk_bf16_f32 v119, v80, v80
  ds_write_b128 v126, v[116:119] offset:4176
L_xvd:
  s_cbranch_vccnz L_gexpret
L_expskip:
  v_mov_b64 v[52:53], 0
  v_mov_b64 v[54:55], 0
  s_cbranch_vccnz L_sk3
  s_add_u32 m0, s75, s72
  s_nop 0
  buffer_load_dwordx4 v10, s[40:43], s64 offen lds
L_sk3:
  s_cbranch_vccnz L_sk4
  buffer_load_dwordx4 v11, s[40:43], s64 offen offset:1024 lds
  v_mfma_f32_32x32x16_bf16 v[144:159], v[52:55], v[52:55], 0
L_sk4:
  s_cbranch_vccnz L_sk5
  buffer_load_dwordx4 v12, s[40:43], s64 offen offset:2048 lds
L_sk5:
  s_cbranch_vccnz L_sk6
  buffer_load_dwordx4 v13, s[40:43], s64 offen offset:3072 lds
L_sk6:
  v_mfma_f32_32x32x16_bf16 v[160:175], v[52:55], v[52:55], 0
  s_cbranch_vccnz L_sk7
  s_add_u32 m0, s75, s73
  s_nop 0
  buffer_load_dwordx4 v14, s[44:47], s65 offen lds
L_sk7:
  s_cbranch_vccnz L_sk8
  buffer_load_dwordx4 v15, s[44:47], s65 offen offset:1024 lds
  v_mfma_f32_32x32x16_bf16 v[176:191], v[52:55], v[52:55], 0
L_sk8:
  s_cbranch_vccnz L_sk9
  buffer_load_dwordx4 v16, s[44:47], s65 offen offset:2048 lds
L_sk9:
  s_cbranch_vccnz L_sk10
  s_add_u32 m0, s75, s74
  v_mfma_f32_32x32x16_bf16 v[192:207], v[52:55], v[52:55], 0
  s_nop 0
  buffer_load_dwordx4 v5, s[48:51], s65 offen lds
L_sk10:
  s_cbranch_vccnz L_sk11
  buffer_load_dwordx4 v6, s[48:51], s65 offen offset:1024 lds
L_sk11:
  s_cbranch_vccnz L_sk12
  v_mfma_f32_32x32x16_bf16 v[208:223], v[52:55], v[52:55], 0
  buffer_load_dwordx4 v7, s[48:51], s65 offen offset:2048 lds
  s_add_u32 s64, s64, s66
  s_sub_u32 s67, s64, s101
  s_min_u32 s64, s64, s67
  s_add_u32 s65, s65, s68
  s_sub_u32 s67, s65, s69
  s_min_u32 s65, s65, s67
L_sk12:
  v_mfma_f32_32x32x16_bf16 v[128:143], v[52:55], v[52:55], 0
  s_waitcnt vmcnt(10) lgkmcnt(0)
  s_barrier
  s_cbranch_vccnz L_gjoin
  ds_read_b64_tr_b16 v[98:99], v62 offset:0
  ds_read_b64_tr_b16 v[100:101], v63 offset:512
  ds_read_b64_tr_b16 v[102:103], v64 offset:0
  ds_read_b64_tr_b16 v[104:105], v65 offset:512
  ds_read_b128 v[32:35], v17
  ds_read_b64_tr_b16 v[40:41], v21 offset:0
  ds_read_b64_tr_b16 v[42:43], v21 offset:768
  ds_read_b128 v[36:39], v17 offset:4096
  ds_read_b64_tr_b16 v[44:45], v22 offset:0
  ds_read_b64_tr_b16 v[46:47], v22 offset:768
  ds_read_b64_tr_b16 v[48:49], v21 offset:12320
  ds_read_b64_tr_b16 v[50:51], v21 offset:13088
  s_mov_b32 s75, 26112
  s_mov_b32 s80, 32768
  s_waitcnt lgkmcnt(10)
  buffer_store_dwordx4 v[98:101], v68, s[56:59], 0 offen sc1
  s_waitcnt lgkmcnt(8)
  buffer_store_dwordx4 v[102:105], v68, s[56:59], s80 offen sc1
L_g1:
  s_waitcnt lgkmcnt(4)
  v_mfma_f32_32x32x16_bf16 v[128:143], v[40:43], v[32:35], v[128:143]
  ds_read_b128 v[52:55], v18
  ds_read_b64_tr_b16 v[60:61], v21 offset:3072
  s_add_u32 m0, s75, s72
  v_add_u32 v17, s70, v17
  v_mfma_f32_32x32x16_bf16 v[176:191], v[40:43], v[36:39], v[176:191]
  ds_read_b64_tr_b16 v[62:63], v21 offset:3840
  ds_read_b128 v[56:59], v18 offset:4096
  buffer_load_dwordx4 v10, s[40:43], s64 offen lds
  s_waitcnt lgkmcnt(4)
  v_mfma_f32_32x32x16_bf16 v[144:159], v[44:47], v[32:35], v[144:159]
  ds_read_b64_tr_b16 v[64:65], v22 offset:3072
  ds_read_b64_tr_b16 v[66:67], v22 offset:3840
  v_add_u32 v18, s70, v18
  v_mfma_f32_32x32x16_bf16 v[192:207], v[44:47], v[36:39], v[192:207]
  ds_read_b64_tr_b16 v[68:69], v21 offset:15392
  ds_read_b64_tr_b16 v[70:71], v21 offset:16160
  buffer_load_dwordx4 v11, s[40:43], s64 offen offset:1024 lds
  v_mfma_f32_32x32x16_bf16 v[160:175], v[48:51], v[32:35], v[160:175]
  buffer_load_dwordx4 v12, s[40:43], s64 offen offset:2048 lds
  v_mfma_f32_32x32x16_bf16 v[208:223], v[48:51], v[36:39], v[208:223]
  buffer_load_dwordx4 v13, s[40:43], s64 offen offset:3072 lds
  s_add_u32 s64, s64, s66
  s_sub_u32 s67, s64, s101
  s_min_u32 s64, s64, s67
  s_waitcnt lgkmcnt(4)
  v_mfma_f32_32x32x16_bf16 v[128:143], v[60:63], v[52:55], v[128:143]
  ds_read_b128 v[32:35], v19
  ds_read_b64_tr_b16 v[40:41], v21 offset:6144
  s_add_u32 m0, s75, s73
  v_mfma_f32_32x32x16_bf16 v[176:191], v[60:63], v[56:59], v[176:191]
  ds_read_b64_tr_b16 v[42:43], v21 offset:6912
  ds_read_b128 v[36:39], v19 offset:4096
  buffer_load_dwordx4 v14, s[44:47], s65 offen lds
  s_waitcnt lgkmcnt(4)
  v_mfma_f32_32x32x16_bf16 v[144:159], v[64:67], v[52:55], v[144:159]
  ds_read_b64_tr_b16 v[44:45], v22 offset:6144
  ds_read_b64_tr_b16 v[46:47], v22 offset:6912
  v_add_u32 v19, s70, v19
  v_mfma_f32_32x32x16_bf16 v[192:207], v[64:67], v[56:59], v[192:207]
  ds_read_b64_tr_b16 v[48:49], v21 offset:18464
  ds_read_b64_tr_b16 v[50:51], v21 offset:19232
  buffer_load_dwordx4 v15, s[44:47], s65 offen offset:1024 lds
  v_mfma_f32_32x32x16_bf16 v[160:175], v[68:71], v[52:55], v[160:175]
  buffer_load_dwordx4 v16, s[44:47], s65 offen offset:2048 lds
  s_add_u32 m0, s75, s74
  v_mfma_f32_32x32x16_bf16 v[208:223], v[68:71], v[56:59], v[208:223]
  buffer_load_dwordx4 v5, s[48:51], s65 offen lds
  s_waitcnt lgkmcnt(4)
  v_mfma_f32_32x32x16_bf16 v[128:143], v[40:43], v[32:35], v[128:143]
  ds_read_b128 v[52:55], v20
  ds_read_b64_tr_b16 v[60:61], v21 offset:9216
  buffer_load_dwordx4 v6, s[48:51], s65 offen offset:1024 lds
  v_mfma_f32_32x32x16_bf16 v[176:191], v[40:43], v[36:39], v[176:191]
  ds_read_b64_tr_b16 v[62:63], v21 offset:9984
  ds_read_b128 v[56:59], v20 offset:4096
  s_waitcnt lgkmcnt(4)
  v_mfma_f32_32x32x16_bf16 v[144:159], v[44:47], v[32:35], v[144:159]
  ds_read_b64_tr_b16 v[64:65], v22 offset:9216
  ds_read_b64_tr_b16 v[66:67], v22 offset:9984
  buffer_load_dwordx4 v7, s[48:51], s65 offen offset:2048 lds
  v_add_u32 v20, s70, v20
  v_mfma_f32_32x32x16_bf16 v[192:207], v[44:47], v[36:39], v[192:207]
  ds_read_b64_tr_b16 v[68:69], v21 offset:21536
  ds_read_b64_tr_b16 v[70:71], v21 offset:22304
  v_add_u32 v22, s70, v22
  v_mfma_f32_32x32x16_bf16 v[160:175], v[48:51], v[32:35], v[160:175]
  v_add_u32 v21, s70, v21
  s_add_u32 s65, s65, s68
  s_sub_u32 s67, s65, s69
  s_min_u32 s65, s65, s67
  v_mfma_f32_32x32x16_bf16 v[208:223], v[48:51], v[36:39], v[208:223]
  s_add_u32 s75, s75, s71
  s_mov_b32 s71, s70
  s_cmp_eq_u32 s75, 67328
  s_cselect_b32 s70, s97, s96
  s_waitcnt lgkmcnt(4)
  v_mfma_f32_32x32x16_bf16 v[128:143], v[60:63], v[52:55], v[128:143]
  s_cmp_eq_u32 s39, 5
  s_cbranch_scc1 L_g1w12
  s_waitcnt vmcnt(10)
L_g1wret:
  v_mfma_f32_32x32x16_bf16 v[176:191], v[60:63], v[56:59], v[176:191]
  s_waitcnt lgkmcnt(0)
  s_barrier
  v_mfma_f32_32x32x16_bf16 v[144:159], v[64:67], v[52:55], v[144:159]
  ds_read_b128 v[32:35], v17
  ds_read_b64_tr_b16 v[40:41], v21 offset:0
  ds_read_b64_tr_b16 v[42:43], v21 offset:768
  v_mfma_f32_32x32x16_bf16 v[192:207], v[64:67], v[56:59], v[192:207]
  ds_read_b128 v[36:39], v17 offset:4096
  ds_read_b64_tr_b16 v[44:45], v22 offset:0
  ds_read_b64_tr_b16 v[46:47], v22 offset:768
  v_mfma_f32_32x32x16_bf16 v[160:175], v[68:71], v[52:55], v[160:175]
  ds_read_b64_tr_b16 v[48:49], v21 offset:12320
  ds_read_b64_tr_b16 v[50:51], v21 offset:13088
  s_cmp_eq_u32 s76, s39
  s_cbranch_scc1 L_g1x
L_g1ret:
  v_mfma_f32_32x32x16_bf16 v[208:223], v[68:71], v[56:59], v[208:223]
  s_sub_u32 s39, s39, 1
  s_cbranch_scc0 L_g1
  global_load_dword v23, v24, s[32:33] sc1
  s_waitcnt lgkmcnt(4)
  v_mfma_f32_32x32x16_bf16 v[128:143], v[40:43], v[32:35], v[128:143]
  ds_read_b128 v[52:55], v18
  ds_read_b64_tr_b16 v[60:61], v21 offset:3072
  s_mov_b32 s14, 0
  s_add_u32 m0, s95, 26112
  v_add_u32 v17, 0x0000a100, v17
  v_mfma_f32_32x32x16_bf16 v[176:191], v[40:43], v[36:39], v[176:191]
  ds_read_b64_tr_b16 v[62:63], v21 offset:3840
  ds_read_b128 v[56:59], v18 offset:4096
  buffer_load_dwordx4 v122, s[16:19], s14 offen lds
  s_waitcnt lgkmcnt(4)
  v_mfma_f32_32x32x16_bf16 v[144:159], v[44:47], v[32:35], v[144:159]
  ds_read_b64_tr_b16 v[64:65], v22 offset:3072
  ds_read_b64_tr_b16 v[66:67], v22 offset:3840
  v_add_u32 v18, 0x0000a100, v18
  v_mfma_f32_32x32x16_bf16 v[192:207], v[44:47], v[36:39], v[192:207]
  ds_read_b64_tr_b16 v[68:69], v21 offset:15392
  ds_read_b64_tr_b16 v[70:71], v21 offset:16160
  buffer_load_dwordx4 v123, s[16:19], s14 offen offset:1024 lds
  v_mfma_f32_32x32x16_bf16 v[160:175], v[48:51], v[32:35], v[160:175]
  buffer_load_dwordx4 v124, s[16:19], s14 offen offset:2048 lds
  v_mfma_f32_32x32x16_bf16 v[208:223], v[48:51], v[36:39], v[208:223]
  buffer_load_dwordx4 v125, s[16:19], s14 offen offset:3072 lds
  s_waitcnt lgkmcnt(4)
  v_mfma_f32_32x32x16_bf16 v[128:143], v[60:63], v[52:55], v[128:143]
  ds_read_b128 v[32:35], v19
  ds_read_b64_tr_b16 v[40:41], v21 offset:6144
  s_mov_b32 s15, 32768
  s_add_u32 m0, s95, 30208
  v_mfma_f32_32x32x16_bf16 v[176:191], v[60:63], v[56:59], v[176:191]
  ds_read_b64_tr_b16 v[42:43], v21 offset:6912
  ds_read_b128 v[36:39], v19 offset:4096
  buffer_load_dwordx4 v122, s[16:19], s15 offen lds
  s_waitcnt lgkmcnt(4)
  v_mfma_f32_32x32x16_bf16 v[144:159], v[64:67], v[52:55], v[144:159]
  ds_read_b64_tr_b16 v[44:45], v22 offset:6144
  ds_read_b64_tr_b16 v[46:47], v22 offset:6912
  v_add_u32 v19, 0x0000a100, v19
  v_mfma_f32_32x32x16_bf16 v[192:207], v[64:67], v[56:59], v[192:207]
  ds_read_b64_tr_b16 v[48:49], v21 offset:18464
  ds_read_b64_tr_b16 v[50:51], v21 offset:19232
  buffer_load_dwordx4 v123, s[16:19], s15 offen offset:1024 lds
  v_mfma_f32_32x32x16_bf16 v[160:175], v[68:71], v[52:55], v[160:175]
  buffer_load_dwordx4 v124, s[16:19], s15 offen offset:2048 lds
  s_mov_b32 s3, 57344
  s_add_u32 m0, s95, 33280
  v_mfma_f32_32x32x16_bf16 v[208:223], v[68:71], v[56:59], v[208:223]
  buffer_load_dwordx4 v122, s[16:19], s3 offen lds
  s_waitcnt lgkmcnt(4)
  v_mfma_f32_32x32x16_bf16 v[128:143], v[40:43], v[32:35], v[128:143]
  ds_read_b128 v[52:55], v20
  ds_read_b64_tr_b16 v[60:61], v21 offset:9216
  buffer_load_dwordx4 v123, s[16:19], s3 offen offset:1024 lds
  v_mfma_f32_32x32x16_bf16 v[176:191], v[40:43], v[36:39], v[176:191]
  ds_read_b64_tr_b16 v[62:63], v21 offset:9984
  ds_read_b128 v[56:59], v20 offset:4096
  s_waitcnt lgkmcnt(4)
  v_mfma_f32_32x32x16_bf16 v[144:159], v[44:47], v[32:35], v[144:159]
  ds_read_b64_tr_b16 v[64:65], v22 offset:9216
  ds_read_b64_tr_b16 v[66:67], v22 offset:9984
  buffer_load_dwordx4 v124, s[16:19], s3 offen offset:2048 lds
  v_add_u32 v20, 0x0000a100, v20
  v_mfma_f32_32x32x16_bf16 v[192:207], v[44:47], v[36:39], v[192:207]
  ds_read_b64_tr_b16 v[68:69], v21 offset:21536
  ds_read_b64_tr_b16 v[70:71], v21 offset:22304
  v_add_u32 v22, 0x0000a100, v22
  v_mfma_f32_32x32x16_bf16 v[160:175], v[48:51], v[32:35], v[160:175]
  v_add_u32 v21, 0x0000a100, v21
  v_mfma_f32_32x32x16_bf16 v[208:223], v[48:51], v[36:39], v[208:223]
  s_waitcnt lgkmcnt(4)
  v_mfma_f32_32x32x16_bf16 v[128:143], v[60:63], v[52:55], v[128:143]
  s_waitcnt vmcnt(10)
  v_mfma_f32_32x32x16_bf16 v[176:191], v[60:63], v[56:59], v[176:191]
  s_waitcnt lgkmcnt(0)
  s_barrier
  v_mfma_f32_32x32x16_bf16 v[144:159], v[64:67], v[52:55], v[144:159]
  ds_read_b128 v[32:35], v17
  ds_read_b64_tr_b16 v[40:41], v21 offset:0
  ds_read_b64_tr_b16 v[42:43], v21 offset:768
  v_mfma_f32_32x32x16_bf16 v[192:207], v[64:67], v[56:59], v[192:207]
  ds_read_b128 v[36:39], v17 offset:4096
  ds_read_b64_tr_b16 v[44:45], v22 offset:0
  ds_read_b64_tr_b16 v[46:47], v22 offset:768
  v_mfma_f32_32x32x16_bf16 v[160:175], v[68:71], v[52:55], v[160:175]
  ds_read_b64_tr_b16 v[48:49], v21 offset:12320
  ds_read_b64_tr_b16 v[50:51], v21 offset:13088
  v_mfma_f32_32x32x16_bf16 v[208:223], v[68:71], v[56:59], v[208:223]
  s_waitcnt lgkmcnt(4)
  v_mfma_f32_32x32x16_bf16 v[128:143], v[40:43], v[32:35], v[128:143]
  ds_read_b128 v[52:55], v18
  ds_read_b64_tr_b16 v[60:61], v21 offset:3072
  s_mov_b32 s14, 81920
  s_add_u32 m0, s95, 67328
  v_mfma_f32_32x32x16_bf16 v[176:191], v[40:43], v[36:39], v[176:191]
  ds_read_b64_tr_b16 v[62:63], v21 offset:3840
  ds_read_b128 v[56:59], v18 offset:4096
  buffer_load_dwordx4 v122, s[16:19], s14 offen lds
  s_waitcnt lgkmcnt(4)
  v_mfma_f32_32x32x16_bf16 v[144:159], v[44:47], v[32:35], v[144:159]
  ds_read_b64_tr_b16 v[64:65], v22 offset:3072
  ds_read_b64_tr_b16 v[66:67], v22 offset:3840
  v_mfma_f32_32x32x16_bf16 v[192:207], v[44:47], v[36:39], v[192:207]
  ds_read_b64_tr_b16 v[68:69], v21 offset:15392
  ds_read_b64_tr_b16 v[70:71], v21 offset:16160
  buffer_load_dwordx4 v123, s[16:19], s14 offen offset:1024 lds
  v_mfma_f32_32x32x16_bf16 v[160:175], v[48:51], v[32:35], v[160:175]
  buffer_load_dwordx4 v124, s[16:19], s14 offen offset:2048 lds
  v_mfma_f32_32x32x16_bf16 v[208:223], v[48:51], v[36:39], v[208:223]
  buffer_load_dwordx4 v125, s[16:19], s14 offen offset:3072 lds
  s_waitcnt lgkmcnt(4)
  v_mfma_f32_32x32x16_bf16 v[128:143], v[60:63], v[52:55], v[128:143]
  ds_read_b128 v[32:35], v19
  ds_read_b64_tr_b16 v[40:41], v21 offset:6144
  s_mov_b32 s15, 114688
  s_add_u32 m0, s95, 71424
  v_mfma_f32_32x32x16_bf16 v[176:191], v[60:63], v[56:59], v[176:191]
  ds_read_b64_tr_b16 v[42:43], v21 offset:6912
  ds_read_b128 v[36:39], v19 offset:4096
  buffer_load_dwordx4 v122, s[16:19], s15 offen lds
  s_waitcnt lgkmcnt(4)
  v_mfma_f32_32x32x16_bf16 v[144:159], v[64:67], v[52:55], v[144:159]
  ds_read_b64_tr_b16 v[44:45], v22 offset:6144
  ds_read_b64_tr_b16 v[46:47], v22 offset:6912
  v_mfma_f32_32x32x16_bf16 v[192:207], v[64:67], v[56:59], v[192:207]
  ds_read_b64_tr_b16 v[48:49], v21 offset:18464
  ds_read_b64_tr_b16 v[50:51], v21 offset:19232
  buffer_load_dwordx4 v123, s[16:19], s15 offen offset:1024 lds
  v_mfma_f32_32x32x16_bf16 v[160:175], v[68:71], v[52:55], v[160:175]
  buffer_load_dwordx4 v124, s[16:19], s15 offen offset:2048 lds
  s_mov_b32 s3, 139264
  s_add_u32 m0, s95, 74496
  v_mfma_f32_32x32x16_bf16 v[208:223], v[68:71], v[56:59], v[208:223]
  buffer_load_dwordx4 v122, s[16:19], s3 offen lds
  s_waitcnt lgkmcnt(4)
  v_mfma_f32_32x32x16_bf16 v[128:143], v[40:43], v[32:35], v[128:143]
  ds_read_b128 v[52:55], v20
  ds_read_b64_tr_b16 v[60:61], v21 offset:9216
  buffer_load_dwordx4 v123, s[16:19], s3 offen offset:1024 lds
  v_mfma_f32_32x32x16_bf16 v[176:191], v[40:43], v[36:39], v[176:191]
  ds_read_b64_tr_b16 v[62:63], v21 offset:9984
  ds_read_b128 v[56:59], v20 offset:4096
  s_waitcnt lgkmcnt(4)
  v_mfma_f32_32x32x16_bf16 v[144:159], v[44:47], v[32:35], v[144:159]
  ds_read_b64_tr_b16 v[64:65], v22 offset:9216
  ds_read_b64_tr_b16 v[66:67], v22 offset:9984
  buffer_load_dwordx4 v124, s[16:19], s3 offen offset:2048 lds
  v_mfma_f32_32x32x16_bf16 v[192:207], v[44:47], v[36:39], v[192:207]
  ds_read_b64_tr_b16 v[68:69], v21 offset:21536
  ds_read_b64_tr_b16 v[70:71], v21 offset:22304
  v_mfma_f32_32x32x16_bf16 v[160:175], v[48:51], v[32:35], v[160:175]
  v_mfma_f32_32x32x16_bf16 v[208:223], v[48:51], v[36:39], v[208:223]
  s_waitcnt lgkmcnt(4)
  v_mfma_f32_32x32x16_bf16 v[128:143], v[60:63], v[52:55], v[128:143]
  v_mfma_f32_32x32x16_bf16 v[176:191], v[60:63], v[56:59], v[176:191]
  s_waitcnt lgkmcnt(0)
  s_barrier
  v_mfma_f32_32x32x16_bf16 v[144:159], v[64:67], v[52:55], v[144:159]
  s_waitcnt vmcnt(20)
  v_cmp_ne_u32 vcc, s77, v23
  v_mfma_f32_32x32x16_bf16 v[192:207], v[64:67], v[56:59], v[192:207]
  s_cbranch_vccnz L_noute
  v_lshlrev_b32 v2, 4, v0
  s_add_u32 s80, s94, 4096
  buffer_load_dwordx4 v[24:27], v2, s[56:59], s94 offen sc1
  buffer_load_dwordx4 v[28:31], v2, s[56:59], s80 offen sc1
  s_mov_b32 s78, 1
L_noute:
  v_mfma_f32_32x32x16_bf16 v[160:175], v[68:71], v[52:55], v[160:175]
  v_mfma_f32_32x32x16_bf16 v[208:223], v[68:71], v[56:59], v[208:223]
  s_mov_b32 s14, 163840
  s_add_u32 m0, s95, 108544
  s_nop 0
  buffer_load_dwordx4 v122, s[16:19], s14 offen lds
  s_nop 6
  v_pk_mul_f32 v[56:57], v[128:129], v[128:129]
  v_pk_mul_f32 v[60:61], v[130:131], v[130:131]
  v_pk_mul_f32 v[64:65], v[132:133], v[132:133]
  v_pk_fma_f32 v[56:57], v[56:57], s[86:87], v[78:79]
  v_pk_fma_f32 v[60:61], v[60:61], s[86:87], v[78:79]
  v_pk_fma_f32 v[64:65], v[64:65], s[86:87], v[78:79]
  v_pk_mul_f32 v[56:57], v[56:57], v[128:129]
  v_pk_mul_f32 v[60:61], v[60:61], v[130:131]
  v_pk_mul_f32 v[64:65], v[64:65], v[132:133]
  buffer_load_dwordx4 v123, s[16:19], s14 offen offset:1024 lds
  v_exp_f32 v58, v56
  v_exp_f32 v59, v57
  v_pk_mul_f32 v[56:57], v[128:129], v[160:161]
  v_exp_f32 v62, v60
  v_pk_add_f32 v[58:59], v[58:59], 1.0 op_sel_hi:[1,0]
  v_exp_f32 v63, v61
  v_pk_mul_f32 v[60:61], v[130:131], v[162:163]
  v_rcp_f32 v58, v58
  v_rcp_f32 v59, v59
  v_pk_add_f32 v[62:63], v[62:63], 1.0 op_sel_hi:[1,0]
  v_exp_f32 v66, v64
  v_pk_mul_f32 v[56:57], v[56:57], v[58:59]
  v_rcp_f32 v62, v62
  v_rcp_f32 v63, v63
  v_cvt_pk_bf16_f32 v32, v56, v57
  v_exp_f32 v67, v65
  v_pk_mul_f32 v[60:61], v[60:61], v[62:63]
  v_pk_mul_f32 v[64:65], v[132:133], v[164:165]
  buffer_load_dwordx4 v124, s[16:19], s14 offen offset:2048 lds
  v_pk_add_f32 v[66:67], v[66:67], 1.0 op_sel_hi:[1,0]
  v_cvt_pk_bf16_f32 v33, v60, v61
  v_pk_mul_f32 v[68:69], v[134:135], v[134:135]
  v_rcp_f32 v66, v66
  v_rcp_f32 v67, v67
  v_pk_fma_f32 v[68:69], v[68:69], s[86:87], v[78:79]
  v_pk_mul_f32 v[80:81], v[136:137], v[136:137]
  v_pk_mul_f32 v[64:65], v[64:65], v[66:67]
  v_pk_mul_f32 v[68:69], v[68:69], v[134:135]
  v_pk_fma_f32 v[80:81], v[80:81], s[86:87], v[78:79]
  v_cvt_pk_bf16_f32 v34, v64, v65
  v_exp_f32 v70, v68
  v_exp_f32 v71, v69
  v_pk_mul_f32 v[68:69], v[134:135], v[166:167]
  v_pk_mul_f32 v[80:81], v[80:81], v[136:137]
  v_pk_add_f32 v[70:71], v[70:71], 1.0 op_sel_hi:[1,0]
  v_pk_mul_f32 v[84:85], v[138:139], v[138:139]
  v_exp_f32 v82, v80
  buffer_load_dwordx4 v125, s[16:19], s14 offen offset:3072 lds
  v_rcp_f32 v70, v70
  v_rcp_f32 v71, v71
  v_exp_f32 v83, v81
  v_pk_mul_f32 v[80:81], v[136:137], v[168:169]
  v_pk_mul_f32 v[68:69], v[68:69], v[70:71]
  v_pk_add_f32 v[82:83], v[82:83], 1.0 op_sel_hi:[1,0]
  v_pk_fma_f32 v[84:85], v[84:85], s[86:87], v[78:79]
  v_cvt_pk_bf16_f32 v35, v68, v69
  v_rcp_f32 v82, v82
  v_rcp_f32 v83, v83
  buffer_store_dwordx4 v[32:35], v228, s[52:55], 0 offen offset:0 sc1
  v_pk_mul_f32 v[84:85], v[84:85], v[138:139]
  v_pk_mul_f32 v[80:81], v[80:81], v[82:83]
  v_pk_mul_f32 v[88:89], v[140:141], v[140:141]
  v_exp_f32 v86, v84
  v_cvt_pk_bf16_f32 v36, v80, v81
  v_exp_f32 v87, v85
  v_pk_mul_f32 v[84:85], v[138:139], v[170:171]
  s_mov_b32 s15, 196608
  s_add_u32 m0, s95, 112640
  s_nop 0
  buffer_load_dwordx4 v122, s[16:19], s15 offen lds
  v_pk_fma_f32 v[88:89], v[88:89], s[86:87], v[78:79]
  v_pk_add_f32 v[86:87], v[86:87], 1.0 op_sel_hi:[1,0]
  v_pk_mul_f32 v[92:93], v[142:143], v[142:143]
  v_pk_mul_f32 v[88:89], v[88:89], v[140:141]
  v_rcp_f32 v86, v86
  v_rcp_f32 v87, v87
  v_exp_f32 v90, v88
  v_exp_f32 v91, v89
  v_pk_mul_f32 v[84:85], v[84:85], v[86:87]
  v_pk_mul_f32 v[88:89], v[140:141], v[172:173]
  v_pk_add_f32 v[90:91], v[90:91], 1.0 op_sel_hi:[1,0]
  v_cvt_pk_bf16_f32 v37, v84, v85
  v_pk_fma_f32 v[92:93], v[92:93], s[86:87], v[78:79]
  v_rcp_f32 v90, v90
  v_rcp_f32 v91, v91
  v_pk_mul_f32 v[92:93], v[92:93], v[142:143]
  v_pk_mul_f32 v[56:57], v[144:145], v[144:145]
  v_pk_mul_f32 v[88:89], v[88:89], v[90:91]
  buffer_load_dwordx4 v123, s[16:19], s15 offen offset:1024 lds
  v_exp_f32 v94, v92
  v_exp_f32 v95, v93
  v_cvt_pk_bf16_f32 v38, v88, v89
  v_pk_mul_f32 v[92:93], v[142:143], v[174:175]
  v_pk_add_f32 v[94:95], v[94:95], 1.0 op_sel_hi:[1,0]
  v_pk_fma_f32 v[56:57], v[56:57], s[86:87], v[78:79]
  v_pk_mul_f32 v[60:61], v[146:147], v[146:147]
  v_rcp_f32 v94, v94
  v_rcp_f32 v95, v95
  v_pk_mul_f32 v[56:57], v[56:57], v[144:145]
  v_pk_fma_f32 v[60:61], v[60:61], s[86:87], v[78:79]
  v_pk_mul_f32 v[92:93], v[92:93], v[94:95]
  v_exp_f32 v58, v56
  v_exp_f32 v59, v57
  v_cvt_pk_bf16_f32 v39, v92, v93
  v_pk_mul_f32 v[56:57], v[144:145], v[152:153]
  v_pk_add_f32 v[58:59], v[58:59], 1.0 op_sel_hi:[1,0]
  buffer_store_dwordx4 v[36:39], v229, s[52:55], 0 offen offset:0 sc1
  buffer_load_dwordx4 v124, s[16:19], s15 offen offset:2048 lds
  v_pk_mul_f32 v[60:61], v[60:61], v[146:147]
  v_rcp_f32 v58, v58
  v_rcp_f32 v59, v59
  v_exp_f32 v62, v60
  v_exp_f32 v63, v61
  v_pk_mul_f32 v[56:57], v[56:57], v[58:59]
  v_pk_mul_f32 v[60:61], v[146:147], v[154:155]
  v_pk_add_f32 v[62:63], v[62:63], 1.0 op_sel_hi:[1,0]
  v_cvt_pk_bf16_f32 v40, v56, v57
  v_pk_mul_f32 v[64:65], v[148:149], v[148:149]
  v_rcp_f32 v62, v62
  v_rcp_f32 v63, v63
  v_pk_fma_f32 v[64:65], v[64:65], s[86:87], v[78:79]
  v_pk_mul_f32 v[68:69], v[150:151], v[150:151]
  v_pk_mul_f32 v[60:61], v[60:61], v[62:63]
  v_pk_mul_f32 v[64:65], v[64:65], v[148:149]
  v_pk_fma_f32 v[68:69], v[68:69], s[86:87], v[78:79]
  v_cvt_pk_bf16_f32 v41, v60, v61
  s_mov_b32 s3, 221184
  s_add_u32 m0, s95, 115712
  s_nop 0
  buffer_load_dwordx4 v122, s[16:19], s3 offen lds
  v_exp_f32 v66, v64
  v_exp_f32 v67, v65
  v_pk_mul_f32 v[64:65], v[148:149], v[156:157]
  v_pk_mul_f32 v[68:69], v[68:69], v[150:151]
  v_pk_add_f32 v[66:67], v[66:67], 1.0 op_sel_hi:[1,0]
  v_pk_mul_f32 v[80:81], v[176:177], v[176:177]
  v_exp_f32 v70, v68
  v_rcp_f32 v66, v66
  v_rcp_f32 v67, v67
  v_exp_f32 v71, v69
  v_pk_mul_f32 v[68:69], v[150:151], v[158:159]
  v_pk_mul_f32 v[64:65], v[64:65], v[66:67]
  v_pk_add_f32 v[70:71], v[70:71], 1.0 op_sel_hi:[1,0]
  v_pk_fma_f32 v[80:81], v[80:81], s[86:87], v[78:79]
  v_cvt_pk_bf16_f32 v42, v64, v65
  v_rcp_f32 v70, v70
  v_rcp_f32 v71, v71
  v_pk_mul_f32 v[80:81], v[80:81], v[176:177]
  buffer_load_dwordx4 v123, s[16:19], s3 offen offset:1024 lds
  v_pk_mul_f32 v[84:85], v[178:179], v[178:179]
  v_pk_mul_f32 v[68:69], v[68:69], v[70:71]
  v_exp_f32 v82, v80
  v_exp_f32 v83, v81
  v_cvt_pk_bf16_f32 v43, v68, v69
  v_pk_mul_f32 v[80:81], v[176:177], v[208:209]
  v_pk_add_f32 v[82:83], v[82:83], 1.0 op_sel_hi:[1,0]
  buffer_store_dwordx4 v[40:43], v230, s[52:55], 0 offen offset:0 sc1
  v_pk_fma_f32 v[84:85], v[84:85], s[86:87], v[78:79]
  v_rcp_f32 v82, v82
  v_rcp_f32 v83, v83
  v_pk_mul_f32 v[84:85], v[84:85], v[178:179]
  v_pk_mul_f32 v[88:89], v[180:181], v[180:181]
  v_pk_mul_f32 v[80:81], v[80:81], v[82:83]
  v_exp_f32 v86, v84
  v_exp_f32 v87, v85
  v_cvt_pk_bf16_f32 v44, v80, v81
  v_pk_mul_f32 v[84:85], v[178:179], v[210:211]
  buffer_load_dwordx4 v124, s[16:19], s3 offen offset:2048 lds
  v_pk_add_f32 v[86:87], v[86:87], 1.0 op_sel_hi:[1,0]
  v_pk_fma_f32 v[88:89], v[88:89], s[86:87], v[78:79]
  v_pk_mul_f32 v[92:93], v[182:183], v[182:183]
  v_rcp_f32 v86, v86
  v_rcp_f32 v87, v87
  v_pk_mul_f32 v[88:89], v[88:89], v[180:181]
  v_pk_fma_f32 v[92:93], v[92:93], s[86:87], v[78:79]
  v_pk_mul_f32 v[84:85], v[84:85], v[86:87]
  v_exp_f32 v90, v88
  v_exp_f32 v91, v89
  v_cvt_pk_bf16_f32 v45, v84, v85
  v_pk_mul_f32 v[88:89], v[180:181], v[212:213]
  v_pk_add_f32 v[90:91], v[90:91], 1.0 op_sel_hi:[1,0]
  v_pk_mul_f32 v[92:93], v[92:93], v[182:183]
  v_pk_mul_f32 v[56:57], v[184:185], v[184:185]
  v_rcp_f32 v90, v90
  v_rcp_f32 v91, v91
  v_exp_f32 v94, v92
  v_exp_f32 v95, v93
  v_pk_mul_f32 v[88:89], v[88:89], v[90:91]
  v_pk_mul_f32 v[92:93], v[182:183], v[214:215]
  v_pk_add_f32 v[94:95], v[94:95], 1.0 op_sel_hi:[1,0]
  v_cvt_pk_bf16_f32 v46, v88, v89
  v_pk_fma_f32 v[56:57], v[56:57], s[86:87], v[78:79]
  v_rcp_f32 v94, v94
  v_rcp_f32 v95, v95
  v_pk_mul_f32 v[56:57], v[56:57], v[184:185]
  v_pk_mul_f32 v[60:61], v[186:187], v[186:187]
  v_pk_mul_f32 v[92:93], v[92:93], v[94:95]
  v_exp_f32 v58, v56
  v_exp_f32 v59, v57
  v_cvt_pk_bf16_f32 v47, v92, v93
  s_waitcnt vmcnt(13)
  ds_write_b128 v252, v[24:27]
  ds_write_b128 v252, v[28:31] offset:4608
  v_pk_mul_f32 v[56:57], v[184:185], v[216:217]
  v_pk_add_f32 v[58:59], v[58:59], 1.0 op_sel_hi:[1,0]
  buffer_store_dwordx4 v[44:47], v228, s[52:55], 0 offen offset:1024 sc1
  v_pk_fma_f32 v[60:61], v[60:61], s[86:87], v[78:79]
  v_rcp_f32 v58, v58
  v_rcp_f32 v59, v59
  v_pk_mul_f32 v[60:61], v[60:61], v[186:187]
  v_pk_mul_f32 v[64:65], v[188:189], v[188:189]
  v_pk_mul_f32 v[56:57], v[56:57], v[58:59]
  v_exp_f32 v62, v60
  v_exp_f32 v63, v61
  v_cvt_pk_bf16_f32 v48, v56, v57
  v_pk_mul_f32 v[60:61], v[186:187], v[218:219]
  v_pk_add_f32 v[62:63], v[62:63], 1.0 op_sel_hi:[1,0]
  v_pk_fma_f32 v[64:65], v[64:65], s[86:87], v[78:79]
  v_pk_mul_f32 v[68:69], v[190:191], v[190:191]
  v_rcp_f32 v62, v62
  v_rcp_f32 v63, v63
  v_pk_mul_f32 v[64:65], v[64:65], v[188:189]
  v_pk_fma_f32 v[68:69], v[68:69], s[86:87], v[78:79]
  v_pk_mul_f32 v[60:61], v[60:61], v[62:63]
  v_exp_f32 v66, v64
  v_exp_f32 v67, v65
  v_cvt_pk_bf16_f32 v49, v60, v61
  v_pk_mul_f32 v[64:65], v[188:189], v[220:221]
  v_pk_add_f32 v[66:67], v[66:67], 1.0 op_sel_hi:[1,0]
  v_pk_mul_f32 v[68:69], v[68:69], v[190:191]
  v_pk_mul_f32 v[80:81], v[192:193], v[192:193]
  v_rcp_f32 v66, v66
  v_rcp_f32 v67, v67
  v_exp_f32 v70, v68
  v_exp_f32 v71, v69
  v_pk_mul_f32 v[64:65], v[64:65], v[66:67]
  v_pk_mul_f32 v[68:69], v[190:191], v[222:223]
  v_pk_add_f32 v[70:71], v[70:71], 1.0 op_sel_hi:[1,0]
  v_cvt_pk_bf16_f32 v50, v64, v65
  v_pk_fma_f32 v[80:81], v[80:81], s[86:87], v[78:79]
  v_rcp_f32 v70, v70
  v_rcp_f32 v71, v71
  v_pk_mul_f32 v[80:81], v[80:81], v[192:193]
  v_pk_mul_f32 v[84:85], v[194:195], v[194:195]
  v_pk_mul_f32 v[68:69], v[68:69], v[70:71]
  v_exp_f32 v82, v80
  v_exp_f32 v83, v81
  v_cvt_pk_bf16_f32 v51, v68, v69
  v_pk_mul_f32 v[80:81], v[192:193], v[200:201]
  v_pk_add_f32 v[82:83], v[82:83], 1.0 op_sel_hi:[1,0]
  buffer_store_dwordx4 v[48:51], v229, s[52:55], 0 offen offset:1024 sc1
  v_pk_fma_f32 v[84:85], v[84:85], s[86:87], v[78:79]
  v_rcp_f32 v82, v82
  v_rcp_f32 v83, v83
  v_pk_mul_f32 v[84:85], v[84:85], v[194:195]
  v_pk_mul_f32 v[88:89], v[196:197], v[196:197]
  v_pk_mul_f32 v[80:81], v[80:81], v[82:83]
  v_exp_f32 v86, v84
  v_exp_f32 v87, v85
  v_cvt_pk_bf16_f32 v52, v80, v81
  v_pk_mul_f32 v[84:85], v[194:195], v[202:203]
  v_pk_add_f32 v[86:87], v[86:87], 1.0 op_sel_hi:[1,0]
  v_pk_fma_f32 v[88:89], v[88:89], s[86:87], v[78:79]
  v_pk_mul_f32 v[92:93], v[198:199], v[198:199]
  v_rcp_f32 v86, v86
  v_rcp_f32 v87, v87
  v_pk_mul_f32 v[88:89], v[88:89], v[196:197]
  v_pk_fma_f32 v[92:93], v[92:93], s[86:87], v[78:79]
  v_pk_mul_f32 v[84:85], v[84:85], v[86:87]
  v_exp_f32 v90, v88
  v_exp_f32 v91, v89
  v_cvt_pk_bf16_f32 v53, v84, v85
  v_pk_mul_f32 v[88:89], v[196:197], v[204:205]
  v_pk_add_f32 v[90:91], v[90:91], 1.0 op_sel_hi:[1,0]
  v_pk_mul_f32 v[92:93], v[92:93], v[198:199]
  v_rcp_f32 v90, v90
  v_rcp_f32 v91, v91
  v_exp_f32 v94, v92
  v_exp_f32 v95, v93
  v_pk_mul_f32 v[88:89], v[88:89], v[90:91]
  v_pk_mul_f32 v[92:93], v[198:199], v[206:207]
  v_pk_add_f32 v[94:95], v[94:95], 1.0 op_sel_hi:[1,0]
  v_cvt_pk_bf16_f32 v54, v88, v89
  v_rcp_f32 v94, v94
  v_rcp_f32 v95, v95
  s_nop 0
  v_pk_mul_f32 v[92:93], v[92:93], v[94:95]
  v_cvt_pk_bf16_f32 v55, v92, v93
  buffer_store_dwordx4 v[52:55], v230, s[52:55], 0 offen offset:1024 sc1
L_post2:
  s_mov_b32 s4, 245760
  s_mov_b32 s5, 278528
  s_mov_b32 s6, 311296
  s_mov_b32 s7, 344064
  s_cmp_eq_u32 s78, 0
  s_cbranch_scc1 L_utslow
L_utret:
  v_mov_b32 v3, s77
  s_waitcnt lgkmcnt(0)
  s_barrier
  ds_read2_b32 v[156:157], v234 offset0:48 offset1:49
  ds_read2_b32 v[158:159], v234 offset0:50 offset1:51
  ds_read_b128 v[160:163], v235 offset:192
  ds_read2_b32 v[152:153], v234 offset0:176 offset1:177
  ds_read2_b32 v[154:155], v234 offset0:178 offset1:179
  ds_read_b128 v[164:167], v235 offset:704
  ds_read2_b32 v[148:149], v233 offset0:48 offset1:49
  ds_read2_b32 v[150:151], v233 offset0:50 offset1:51
  ds_read_b128 v[168:171], v235 offset:1216
  ds_read2_b32 v[144:145], v233 offset0:176 offset1:177
  ds_read2_b32 v[146:147], v233 offset0:178 offset1:179
  ds_read_b128 v[172:175], v235 offset:1728
  ds_read2_b32 v[140:141], v232 offset0:48 offset1:49
  ds_read2_b32 v[142:143], v232 offset0:50 offset1:51
  ds_read_b128 v[176:179], v235 offset:2240
  ds_read2_b32 v[136:137], v232 offset0:176 offset1:177
  ds_read2_b32 v[138:139], v232 offset0:178 offset1:179
  ds_read_b128 v[180:183], v235 offset:2752
  ds_read2_b32 v[132:133], v231 offset0:48 offset1:49
  ds_read2_b32 v[134:135], v231 offset0:50 offset1:51
  ds_read_b128 v[184:187], v235 offset:3264
  ds_read2_b32 v[128:129], v231 offset0:176 offset1:177
  ds_read2_b32 v[130:131], v231 offset0:178 offset1:179
  ds_read_b128 v[188:191], v235 offset:3776
  s_waitcnt vmcnt(16)
  s_waitcnt lgkmcnt(15)
  v_mfma_f32_16x16x32_bf16 v[220:223], v[156:159], v[160:163], 0
  s_waitcnt lgkmcnt(15)
  v_mfma_f32_16x16x32_bf16 v[216:219], v[152:155], v[160:163], 0
  ds_read_b64_tr_b16 a[0:1], v224 offset:0
  v_mfma_f32_16x16x32_bf16 v[220:223], v[152:155], v[164:167], v[220:223]
  s_waitcnt lgkmcnt(15)
  v_mfma_f32_16x16x32_bf16 v[212:215], v[148:151], v[160:163], 0
  ds_read2_b32 v[60:61], v234 offset0:32 offset1:33
  ds_read_b64_tr_b16 a[2:3], v224 offset:1024
  v_mfma_f32_16x16x32_bf16 v[216:219], v[148:151], v[164:167], v[216:219]
  ds_read2_b32 v[62:63], v234 offset0:34 offset1:35
  ds_read_b64_tr_b16 a[4:5], v225 offset:0
  v_mfma_f32_16x16x32_bf16 v[220:223], v[148:151], v[168:171], v[220:223]
  ds_read_b128 v[64:67], v235 offset:128
  s_waitcnt lgkmcnt(15)
  v_mfma_f32_16x16x32_bf16 v[208:211], v[144:147], v[160:163], 0
  ds_read_b64_tr_b16 a[6:7], v225 offset:1024
  ds_read2_b32 v[56:57], v234 offset0:160 offset1:161
  v_mfma_f32_16x16x32_bf16 v[212:215], v[144:147], v[164:167], v[212:215]
  ds_read2_b32 v[58:59], v234 offset0:162 offset1:163
  ds_read_b64_tr_b16 a[8:9], v224 offset:2048
  v_mfma_f32_16x16x32_bf16 v[216:219], v[144:147], v[168:171], v[216:219]
  ds_read_b128 v[68:71], v235 offset:640
  v_mfma_f32_16x16x32_bf16 v[220:223], v[144:147], v[172:175], v[220:223]
  ds_read_b64_tr_b16 a[10:11], v224 offset:3072
  s_waitcnt lgkmcnt(15)
  v_mfma_f32_16x16x32_bf16 v[204:207], v[140:143], v[160:163], 0
  s_waitcnt vmcnt(0)
  s_mov_b64 exec, 1
  global_store_dword v236, v3, s[32:33] sc1
  s_mov_b64 exec, -1
  v_mfma_f32_16x16x32_bf16 v[208:211], v[140:143], v[164:167], v[208:211]
  ds_read2_b32 v[52:53], v233 offset0:32 offset1:33
  ds_read_b64_tr_b16 a[12:13], v225 offset:2048
  v_mfma_f32_16x16x32_bf16 v[212:215], v[140:143], v[168:171], v[212:215]
  ds_read2_b32 v[54:55], v233 offset0:34 offset1:35
  ds_read_b128 v[72:75], v235 offset:1152
  v_mfma_f32_16x16x32_bf16 v[216:219], v[140:143], v[172:175], v[216:219]
  ds_read_b64_tr_b16 a[14:15], v225 offset:3072
  ds_read2_b32 v[48:49], v233 offset0:160 offset1:161
  v_mfma_f32_16x16x32_bf16 v[220:223], v[140:143], v[176:179], v[220:223]
  ds_read_b64_tr_b16 a[16:17], v224 offset:4096
  ds_read2_b32 v[50:51], v233 offset0:162 offset1:163
  s_waitcnt lgkmcnt(15)
  v_mfma_f32_16x16x32_bf16 v[200:203], v[136:139], v[160:163], 0
  ds_read_b64_tr_b16 a[18:19], v224 offset:5120
  ds_read_b128 v[76:79], v235 offset:1664
  v_mfma_f32_16x16x32_bf16 v[204:207], v[136:139], v[164:167], v[204:207]
  ds_read2_b32 v[44:45], v232 offset0:32 offset1:33
  ds_read_b64_tr_b16 a[20:21], v225 offset:4096
  v_mfma_f32_16x16x32_bf16 v[208:211], v[136:139], v[168:171], v[208:211]
  v_mfma_f32_16x16x32_bf16 v[212:215], v[136:139], v[172:175], v[212:215]
  ds_read2_b32 v[46:47], v232 offset0:34 offset1:35
  ds_read_b64_tr_b16 a[22:23], v225 offset:5120
  v_mfma_f32_16x16x32_bf16 v[216:219], v[136:139], v[176:179], v[216:219]
  ds_read_b128 v[80:83], v235 offset:2176
  v_mfma_f32_16x16x32_bf16 v[220:223], v[136:139], v[180:183], v[220:223]
  ds_read_b64_tr_b16 a[24:25], v224 offset:6144
  s_waitcnt lgkmcnt(15)
  v_mfma_f32_16x16x32_bf16 v[196:199], v[132:135], v[160:163], 0
  ds_read2_b32 v[40:41], v232 offset0:160 offset1:161
  ds_read2_b32 v[42:43], v232 offset0:162 offset1:163
  v_mfma_f32_16x16x32_bf16 v[200:203], v[132:135], v[164:167], v[200:203]
  ds_read_b64_tr_b16 a[26:27], v224 offset:7168
  v_mfma_f32_16x16x32_bf16 v[204:207], v[132:135], v[168:171], v[204:207]
  ds_read_b128 v[84:87], v235 offset:2688
  ds_read_b64_tr_b16 a[28:29], v225 offset:6144
  v_mfma_f32_16x16x32_bf16 v[208:211], v[132:135], v[172:175], v[208:211]
  ds_read2_b32 v[36:37], v231 offset0:32 offset1:33
  v_mfma_f32_16x16x32_bf16 v[212:215], v[132:135], v[176:179], v[212:215]
  ds_read_b64_tr_b16 a[30:31], v225 offset:7168
  ds_read2_b32 v[38:39], v231 offset0:34 offset1:35
  v_mfma_f32_16x16x32_bf16 v[216:219], v[132:135], v[180:183], v[216:219]
  v_mfma_f32_16x16x32_bf16 v[220:223], v[132:135], v[184:187], v[220:223]
  ds_read_b128 v[88:91], v235 offset:3200
  ds_read_b64_tr_b16 a[32:33], v224 offset:8192
  s_waitcnt lgkmcnt(15)
  v_mfma_f32_16x16x32_bf16 v[192:195], v[128:131], v[160:163], 0
  ds_read2_b32 v[32:33], v231 offset0:160 offset1:161
  ds_read_b64_tr_b16 a[34:35], v224 offset:9216
  v_mfma_f32_16x16x32_bf16 v[196:199], v[128:131], v[164:167], v[196:199]
  ds_read2_b32 v[34:35], v231 offset0:162 offset1:163
  v_mfma_f32_16x16x32_bf16 v[200:203], v[128:131], v[168:171], v[200:203]
  ds_read_b64_tr_b16 a[36:37], v225 offset:8192
  ds_read_b128 v[92:95], v235 offset:3712
  v_mfma_f32_16x16x32_bf16 v[204:207], v[128:131], v[172:175], v[204:207]
  v_mfma_f32_16x16x32_bf16 v[208:211], v[128:131], v[176:179], v[208:211]
  ds_read_b64_tr_b16 a[38:39], v225 offset:9216
  v_mfma_f32_16x16x32_bf16 v[212:215], v[128:131], v[180:183], v[212:215]
  v_mfma_f32_16x16x32_bf16 v[216:219], v[128:131], v[184:187], v[216:219]
  v_mfma_f32_16x16x32_bf16 v[220:223], v[128:131], v[188:191], v[220:223]
  s_lshl_b32 s80, s2, 2
  s_add_u32 s80, s80, s34
  s_cmp_eq_u32 s80, 3
  s_cbranch_scc1 L_epoch
L_epret:
  s_waitcnt lgkmcnt(0)
  v_mfma_f32_16x16x32_bf16 v[220:223], v[60:63], v[64:67], v[220:223]
  ds_read2_b32 v[156:157], v234 offset0:16 offset1:17
  v_mfma_f32_16x16x32_bf16 v[216:219], v[56:59], v[64:67], v[216:219]
  ds_read_b64_tr_b16 a[40:41], v224 offset:41216
  s_add_u32 m0, s95, 26112
  v_mfma_f32_16x16x32_bf16 v[220:223], v[56:59], v[68:71], v[220:223]
  ds_read2_b32 v[158:159], v234 offset0:18 offset1:19
  v_and_b32 v104, 31, v1
  v_mfma_f32_16x16x32_bf16 v[212:215], v[52:55], v[64:67], v[212:215]
  ds_read_b64_tr_b16 a[42:43], v224 offset:42240
  ds_read_b128 v[160:163], v235 offset:64
  v_mfma_f32_16x16x32_bf16 v[216:219], v[52:55], v[68:71], v[216:219]
  buffer_load_dwordx4 v122, s[16:19], s4 offen offset:0 lds
  ds_read2_b32 v[152:153], v234 offset0:144 offset1:145
  v_mfma_f32_16x16x32_bf16 v[220:223], v[52:55], v[72:75], v[220:223]
  ds_read_b64_tr_b16 a[44:45], v225 offset:41216
  ds_read2_b32 v[154:155], v234 offset0:146 offset1:147
  v_mfma_f32_16x16x32_bf16 v[208:211], v[48:51], v[64:67], v[208:211]
  buffer_load_dwordx4 v123, s[16:19], s4 offen offset:1024 lds
  v_mfma_f32_16x16x32_bf16 v[212:215], v[48:51], v[68:71], v[212:215]
  ds_read_b128 v[164:167], v235 offset:576
  ds_read_b64_tr_b16 a[46:47], v225 offset:42240
  v_mfma_f32_16x16x32_bf16 v[216:219], v[48:51], v[72:75], v[216:219]
  ds_read2_b32 v[148:149], v233 offset0:16 offset1:17
  v_lshrrev_b32 v105, 5, v1
  v_mfma_f32_16x16x32_bf16 v[220:223], v[48:51], v[76:79], v[220:223]
  ds_read_b64_tr_b16 a[48:49], v224 offset:43264
  ds_read2_b32 v[150:151], v233 offset0:18 offset1:19
  v_mfma_f32_16x16x32_bf16 v[204:207], v[44:47], v[64:67], v[204:207]
  buffer_load_dwordx4 v124, s[16:19], s4 offen offset:2048 lds
  ds_read_b128 v[168:171], v235 offset:1088
  v_mfma_f32_16x16x32_bf16 v[208:211], v[44:47], v[68:71], v[208:211]
  ds_read_b64_tr_b16 a[50:51], v224 offset:44288
  v_mfma_f32_16x16x32_bf16 v[212:215], v[44:47], v[72:75], v[212:215]
  ds_read2_b32 v[144:145], v233 offset0:144 offset1:145
  buffer_load_dwordx4 v125, s[16:19], s4 offen offset:3072 lds
  v_mfma_f32_16x16x32_bf16 v[216:219], v[44:47], v[76:79], v[216:219]
  ds_read_b64_tr_b16 a[52:53], v225 offset:43264
  ds_read2_b32 v[146:147], v233 offset0:146 offset1:147
  v_mfma_f32_16x16x32_bf16 v[220:223], v[44:47], v[80:83], v[220:223]
  ds_read_b128 v[172:175], v235 offset:1600
  v_lshlrev_b32 v106, 4, v1
  v_mfma_f32_16x16x32_bf16 v[200:203], v[40:43], v[64:67], v[200:203]
  ds_read_b64_tr_b16 a[54:55], v225 offset:44288
  s_add_u32 m0, s95, 30208
  v_mfma_f32_16x16x32_bf16 v[204:207], v[40:43], v[68:71], v[204:207]
  ds_read2_b32 v[140:141], v232 offset0:16 offset1:17
  v_mfma_f32_16x16x32_bf16 v[208:211], v[40:43], v[72:75], v[208:211]
  ds_read2_b32 v[142:143], v232 offset0:18 offset1:19
  ds_read_b64_tr_b16 a[56:57], v224 offset:45312
  v_mfma_f32_16x16x32_bf16 v[212:215], v[40:43], v[76:79], v[212:215]
  buffer_load_dwordx4 v122, s[16:19], s5 offen offset:0 lds
  ds_read_b128 v[176:179], v235 offset:2112
  v_mfma_f32_16x16x32_bf16 v[216:219], v[40:43], v[80:83], v[216:219]
  ds_read_b64_tr_b16 a[58:59], v224 offset:46336
  ds_read2_b32 v[136:137], v232 offset0:144 offset1:145
  v_mfma_f32_16x16x32_bf16 v[220:223], v[40:43], v[84:87], v[220:223]
  buffer_load_dwordx4 v123, s[16:19], s5 offen offset:1024 lds
  s_lshl_b32 s82, s37, 7
  v_mfma_f32_16x16x32_bf16 v[196:199], v[36:39], v[64:67], v[196:199]
  ds_read2_b32 v[138:139], v232 offset0:146 offset1:147
  ds_read_b64_tr_b16 a[60:61], v225 offset:45312
  v_mfma_f32_16x16x32_bf16 v[200:203], v[36:39], v[68:71], v[200:203]
  ds_read_b128 v[180:183], v235 offset:2624
  v_mfma_f32_16x16x32_bf16 v[204:207], v[36:39], v[72:75], v[204:207]
  ds_read_b64_tr_b16 a[62:63], v225 offset:46336
  buffer_load_dwordx4 v124, s[16:19], s5 offen offset:2048 lds
  v_mfma_f32_16x16x32_bf16 v[208:211], v[36:39], v[76:79], v[208:211]
  ds_read2_b32 v[132:133], v231 offset0:16 offset1:17
  ds_read2_b32 v[134:135], v231 offset0:18 offset1:19
  v_mfma_f32_16x16x32_bf16 v[212:215], v[36:39], v[80:83], v[212:215]
  ds_read_b64_tr_b16 a[64:65], v224 offset:47360
  v_mfma_f32_16x16x32_bf16 v[216:219], v[36:39], v[84:87], v[216:219]
  ds_read_b128 v[184:187], v235 offset:3136
  buffer_load_dwordx4 v125, s[16:19], s5 offen offset:3072 lds
  v_mfma_f32_16x16x32_bf16 v[220:223], v[36:39], v[88:91], v[220:223]
  s_add_u32 s82, s82, 0x00a10000
  ds_read_b64_tr_b16 a[66:67], v224 offset:48384
  v_mfma_f32_16x16x32_bf16 v[192:195], v[32:35], v[64:67], v[192:195]
  ds_read2_b32 v[128:129], v231 offset0:144 offset1:145
  ds_read2_b32 v[130:131], v231 offset0:146 offset1:147
  v_mfma_f32_16x16x32_bf16 v[196:199], v[32:35], v[68:71], v[196:199]
  s_add_u32 m0, s95, 34304
  ds_read_b64_tr_b16 a[68:69], v225 offset:47360
  v_mfma_f32_16x16x32_bf16 v[200:203], v[32:35], v[72:75], v[200:203]
  ds_read_b128 v[188:191], v235 offset:3648
  v_mfma_f32_16x16x32_bf16 v[204:207], v[32:35], v[76:79], v[204:207]
  ds_read_b64_tr_b16 a[70:71], v225 offset:48384
  buffer_load_dwordx4 v122, s[16:19], s7 offen offset:0 lds
  v_mfma_f32_16x16x32_bf16 v[208:211], v[32:35], v[80:83], v[208:211]
  v_lshl_add_u32 v239, v104, 2, s82
  v_mfma_f32_16x16x32_bf16 v[212:215], v[32:35], v[84:87], v[212:215]
  v_mfma_f32_16x16x32_bf16 v[216:219], v[32:35], v[88:91], v[216:219]
  buffer_load_dwordx4 v123, s[16:19], s7 offen offset:1024 lds
  v_mfma_f32_16x16x32_bf16 v[220:223], v[32:35], v[92:95], v[220:223]
  s_waitcnt lgkmcnt(0)
  v_mfma_f32_16x16x32_bf16 v[220:223], v[156:159], v[160:163], v[220:223]
  s_xor_b32 s84, s11, 0
  ds_read2_b32 v[60:61], v234 offset0:0 offset1:1
  v_mfma_f32_16x16x32_bf16 v[216:219], v[152:155], v[160:163], v[216:219]
  s_and_b32 s84, s84, 1
  ds_read2_b32 v[62:63], v234 offset0:2 offset1:3
  v_mfma_f32_16x16x32_bf16 v[220:223], v[152:155], v[164:167], v[220:223]
  s_lshl_b32 s82, s37, 1
  v_mfma_f32_16x16x32_bf16 v[212:215], v[148:151], v[160:163], v[212:215]
  ds_read_b128 v[64:67], v235 offset:0
  s_add_u32 s84, s84, s82
  v_mfma_f32_16x16x32_bf16 v[216:219], v[148:151], v[164:167], v[216:219]
  s_add_u32 m0, s95, 67328
  ds_read2_b32 v[56:57], v234 offset0:128 offset1:129
  v_mfma_f32_16x16x32_bf16 v[220:223], v[148:151], v[168:171], v[220:223]
  s_mul_i32 s82, s34, 1408
  s_add_u32 s82, s82, s84
  v_mfma_f32_16x16x32_bf16 v[208:211], v[144:147], v[160:163], v[208:211]
  ds_read2_b32 v[58:59], v234 offset0:130 offset1:131
  s_lshl_b32 s82, s82, 10
  v_mfma_f32_16x16x32_bf16 v[212:215], v[144:147], v[164:167], v[212:215]
  ds_read_b128 v[68:71], v235 offset:512
  v_add_u32 v240, s82, v106
  v_mfma_f32_16x16x32_bf16 v[216:219], v[144:147], v[168:171], v[216:219]
  ds_read2_b32 v[52:53], v233 offset0:0 offset1:1
  v_xor_b32 v241, 1024, v240
  v_mfma_f32_16x16x32_bf16 v[220:223], v[144:147], v[172:175], v[220:223]
  v_add_u32 v106, 26112, v106
  ds_read2_b32 v[54:55], v233 offset0:2 offset1:3
  v_mfma_f32_16x16x32_bf16 v[204:207], v[140:143], v[160:163], v[204:207]
  s_lshl_b32 s82, s84, 7
  buffer_load_dwordx4 v122, s[16:19], s6 offen offset:0 lds
  v_mfma_f32_16x16x32_bf16 v[208:211], v[140:143], v[164:167], v[208:211]
  ds_read_b128 v[72:75], v235 offset:1024
  s_add_u32 s82, s82, 0x00a00000
  v_mfma_f32_16x16x32_bf16 v[212:215], v[140:143], v[168:171], v[212:215]
  ds_read2_b32 v[48:49], v233 offset0:128 offset1:129
  v_lshl_add_u32 v242, v104, 2, s82
  v_mfma_f32_16x16x32_bf16 v[216:219], v[140:143], v[172:175], v[216:219]
  ds_read2_b32 v[50:51], v233 offset0:130 offset1:131
  s_lshl_b32 s82, s84, 15
  v_mfma_f32_16x16x32_bf16 v[220:223], v[140:143], v[176:179], v[220:223]
  s_lshl_b32 s83, s38, 1
  ds_read_b128 v[76:79], v235 offset:1536
  v_mfma_f32_16x16x32_bf16 v[200:203], v[136:139], v[160:163], v[200:203]
  s_add_u32 s83, s83, s12
  ds_read2_b32 v[44:45], v232 offset0:0 offset1:1
  v_mfma_f32_16x16x32_bf16 v[204:207], v[136:139], v[164:167], v[204:207]
  s_lshl_b32 s85, s83, 6
  v_mfma_f32_16x16x32_bf16 v[208:211], v[136:139], v[168:171], v[208:211]
  ds_read2_b32 v[46:47], v232 offset0:2 offset1:3
  s_add_u32 s82, s82, s85
  v_mfma_f32_16x16x32_bf16 v[212:215], v[136:139], v[172:175], v[212:215]
  buffer_load_dwordx4 v123, s[16:19], s6 offen offset:1024 lds
  ds_read_b128 v[80:83], v235 offset:2048
  v_mfma_f32_16x16x32_bf16 v[216:219], v[136:139], v[176:179], v[216:219]
  v_lshlrev_b32 v107, 4, v105
  v_lshl_add_u32 v107, v104, 10, v107
  v_mfma_f32_16x16x32_bf16 v[220:223], v[136:139], v[180:183], v[220:223]
  ds_read2_b32 v[40:41], v232 offset0:128 offset1:129
  v_add_u32 v244, s82, v107
  v_mfma_f32_16x16x32_bf16 v[196:199], v[132:135], v[160:163], v[196:199]
  ds_read2_b32 v[42:43], v232 offset0:130 offset1:131
  s_lshr_b32 s82, s84, 5
  v_mfma_f32_16x16x32_bf16 v[200:203], v[132:135], v[164:167], v[200:203]
  ds_read_b128 v[84:87], v235 offset:2560
  s_lshl_b32 s82, s82, 4
  v_mfma_f32_16x16x32_bf16 v[204:207], v[132:135], v[168:171], v[204:207]
  s_add_u32 s82, s82, s83
  ds_read2_b32 v[36:37], v231 offset0:0 offset1:1
  v_mfma_f32_16x16x32_bf16 v[208:211], v[132:135], v[172:175], v[208:211]
  s_lshl_b32 s82, s82, 7
  ds_read2_b32 v[38:39], v231 offset0:2 offset1:3
  v_mfma_f32_16x16x32_bf16 v[212:215], v[132:135], v[176:179], v[212:215]
  buffer_load_dwordx4 v124, s[16:19], s6 offen offset:2048 lds
  s_add_u32 s82, s82, 0x00a20000
  v_mfma_f32_16x16x32_bf16 v[216:219], v[132:135], v[180:183], v[216:219]
  ds_read_b128 v[88:91], v235 offset:3072
  v_lshl_add_u32 v237, v104, 2, s82
  v_mfma_f32_16x16x32_bf16 v[220:223], v[132:135], v[184:187], v[220:223]
  ds_read2_b32 v[32:33], v231 offset0:128 offset1:129
  s_lshl_b32 s82, s12, 9
  v_mfma_f32_16x16x32_bf16 v[192:195], v[128:131], v[160:163], v[192:195]
  s_add_u32 s82, s82, s11
  ds_read2_b32 v[34:35], v231 offset0:130 offset1:131
  v_mfma_f32_16x16x32_bf16 v[196:199], v[128:131], v[164:167], v[196:199]
  s_lshl_b32 s82, s82, 2
  ds_read_b128 v[92:95], v235 offset:3584
  v_mfma_f32_16x16x32_bf16 v[200:203], v[128:131], v[168:171], v[200:203]
  s_lshl_b32 s85, s2, 3
  v_mfma_f32_16x16x32_bf16 v[204:207], v[128:131], v[172:175], v[204:207]
  s_add_u32 s82, s82, s85
  v_mfma_f32_16x16x32_bf16 v[208:211], v[128:131], v[176:179], v[208:211]
  buffer_load_dwordx4 v125, s[16:19], s6 offen offset:3072 lds
  s_add_u32 s82, s82, 0x00a20000
  v_mfma_f32_16x16x32_bf16 v[212:215], v[128:131], v[180:183], v[212:215]
  v_mov_b32 v243, s82
  v_mfma_f32_16x16x32_bf16 v[216:219], v[128:131], v[184:187], v[216:219]
  s_lshl_b32 s83, s83, 17
  v_mfma_f32_16x16x32_bf16 v[220:223], v[128:131], v[188:191], v[220:223]
  s_lshl_b32 s84, s84, 6
  s_waitcnt lgkmcnt(0)
  v_mfma_f32_16x16x32_bf16 v[220:223], v[60:63], v[64:67], v[220:223]
  s_add_u32 s83, s83, s84
  ds_read_b64_tr_b16 a[72:73], v224 offset:49408
  v_mfma_f32_16x16x32_bf16 v[216:219], v[56:59], v[64:67], v[216:219]
  s_add_u32 s83, s83, 0x00c00000
  v_mfma_f32_16x16x32_bf16 v[220:223], v[56:59], v[68:71], v[220:223]
  ds_read_b64_tr_b16 a[74:75], v224 offset:50432
  v_mfma_f32_16x16x32_bf16 v[212:215], v[52:55], v[64:67], v[212:215]
  v_lshrrev_b32 v107, 2, v1
  v_mfma_f32_16x16x32_bf16 v[216:219], v[52:55], v[68:71], v[216:219]
  ds_read_b64_tr_b16 a[76:77], v225 offset:49408
  v_and_b32 v108, 3, v1
  v_mfma_f32_16x16x32_bf16 v[220:223], v[52:55], v[72:75], v[220:223]
  v_lshlrev_b32 v108, 4, v108
  v_mfma_f32_16x16x32_bf16 v[208:211], v[48:51], v[64:67], v[208:211]
  ds_read_b64_tr_b16 a[78:79], v225 offset:50432
  v_mfma_f32_16x16x32_bf16 v[212:215], v[48:51], v[68:71], v[212:215]
  v_lshl_add_u32 v107, v107, 12, v108
  v_mfma_f32_16x16x32_bf16 v[216:219], v[48:51], v[72:75], v[216:219]
  ds_read_b64_tr_b16 a[80:81], v226 offset:0
  v_add_u32 v245, s83, v107
  v_mfma_f32_16x16x32_bf16 v[220:223], v[48:51], v[76:79], v[220:223]
  ds_read_b64_tr_b16 a[82:83], v226 offset:1024
  s_add_u32 s82, s95, 75520
  v_mfma_f32_16x16x32_bf16 v[204:207], v[44:47], v[64:67], v[204:207]
  v_mfma_f32_16x16x32_bf16 v[208:211], v[44:47], v[68:71], v[208:211]
  v_lshl_add_u32 v246, v1, 4, s82
  ds_read_b64_tr_b16 a[84:85], v227 offset:0
  v_mfma_f32_16x16x32_bf16 v[212:215], v[44:47], v[72:75], v[212:215]
  v_bfe_u32 v107, v1, 2, 2
  v_mfma_f32_16x16x32_bf16 v[216:219], v[44:47], v[76:79], v[216:219]
  ds_read_b64_tr_b16 a[86:87], v227 offset:1024
  v_lshl_add_u32 v107, v105, 2, v107
  v_mfma_f32_16x16x32_bf16 v[220:223], v[44:47], v[80:83], v[220:223]
  v_mfma_f32_16x16x32_bf16 v[200:203], v[40:43], v[64:67], v[200:203]
  ds_read_b64_tr_b16 a[88:89], v226 offset:2048
  v_lshlrev_b32 v107, 6, v107
  v_mfma_f32_16x16x32_bf16 v[204:207], v[40:43], v[68:71], v[204:207]
  v_bfe_u32 v108, v1, 4, 1
  v_mfma_f32_16x16x32_bf16 v[208:211], v[40:43], v[72:75], v[208:211]
  ds_read_b64_tr_b16 a[90:91], v226 offset:3072
  v_lshl_add_u32 v107, v108, 5, v107
  v_mfma_f32_16x16x32_bf16 v[212:215], v[40:43], v[76:79], v[212:215]
  ds_read_b64_tr_b16 a[92:93], v227 offset:2048
  v_mfma_f32_16x16x32_bf16 v[216:219], v[40:43], v[80:83], v[216:219]
  v_and_b32 v108, 3, v1
  v_mfma_f32_16x16x32_bf16 v[220:223], v[40:43], v[84:87], v[220:223]
  v_lshl_add_u32 v107, v108, 3, v107
  ds_read_b64_tr_b16 a[94:95], v227 offset:3072
  v_mfma_f32_16x16x32_bf16 v[196:199], v[36:39], v[64:67], v[196:199]
  v_add_u32 v247, s82, v107
  v_mfma_f32_16x16x32_bf16 v[200:203], v[36:39], v[68:71], v[200:203]
  ds_read_b64_tr_b16 a[96:97], v226 offset:4096
  v_mfma_f32_16x16x32_bf16 v[204:207], v[36:39], v[72:75], v[204:207]
  s_xor_b32 s82, s34, 1
  v_mfma_f32_16x16x32_bf16 v[208:211], v[36:39], v[76:79], v[208:211]
  ds_read_b64_tr_b16 a[98:99], v226 offset:5120
  s_mul_i32 s82, s82, 10240
  v_mfma_f32_16x16x32_bf16 v[212:215], v[36:39], v[80:83], v[212:215]
  v_add_u32 v248, s82, v106
  v_mfma_f32_16x16x32_bf16 v[216:219], v[36:39], v[84:87], v[216:219]
  ds_read_b64_tr_b16 a[100:101], v227 offset:4096
  v_mfma_f32_16x16x32_bf16 v[220:223], v[36:39], v[88:91], v[220:223]
  s_xor_b32 s82, s34, 2
  ds_read_b64_tr_b16 a[102:103], v227 offset:5120
  v_mfma_f32_16x16x32_bf16 v[192:195], v[32:35], v[64:67], v[192:195]
  s_mul_i32 s82, s82, 10240
  v_mfma_f32_16x16x32_bf16 v[196:199], v[32:35], v[68:71], v[196:199]
  v_add_u32 v249, s82, v106
  v_mfma_f32_16x16x32_bf16 v[200:203], v[32:35], v[72:75], v[200:203]
  v_mfma_f32_16x16x32_bf16 v[204:207], v[32:35], v[76:79], v[204:207]
  s_xor_b32 s82, s34, 3
  v_mfma_f32_16x16x32_bf16 v[208:211], v[32:35], v[80:83], v[208:211]
  global_load_dword v23, v239, s[32:33] sc1
  s_mul_i32 s82, s82, 10240
  v_mfma_f32_16x16x32_bf16 v[212:215], v[32:35], v[84:87], v[212:215]
  v_add_u32 v250, s82, v106
  v_mfma_f32_16x16x32_bf16 v[216:219], v[32:35], v[88:91], v[216:219]
  v_mfma_f32_16x16x32_bf16 v[220:223], v[32:35], v[92:95], v[220:223]
  v_add_u32 v251, s95, v106
  s_waitcnt lgkmcnt(0)
  s_nop 4
  s_bitcmp1_b32 s34, 0
  s_cbranch_scc0 L_xeven
  ds_write_b128 v251, v[192:195] offset:45312
  ds_write_b128 v251, v[196:199] offset:46336
  ds_write_b128 v251, v[200:203] offset:47360
  ds_write_b128 v251, v[204:207] offset:48384
  s_waitcnt lgkmcnt(0)
  v_mov_b64 v[192:193], v[208:209]
  v_mov_b64 v[194:195], v[210:211]
  v_mov_b64 v[196:197], v[212:213]
  v_mov_b64 v[198:199], v[214:215]
  v_mov_b64 v[200:201], v[216:217]
  v_mov_b64 v[202:203], v[218:219]
  v_mov_b64 v[204:205], v[220:221]
  v_mov_b64 v[206:207], v[222:223]
  s_branch L_xret
L_xeven:
  ds_write_b128 v251, v[208:211] offset:45312
  ds_write_b128 v251, v[212:215] offset:46336
  ds_write_b128 v251, v[216:219] offset:47360
  ds_write_b128 v251, v[220:223] offset:48384
  s_waitcnt lgkmcnt(0)
L_xret:
  s_barrier
  ds_read_b128 v[208:211], v248 offset:45312
  ds_read_b128 v[212:215], v248 offset:46336
  ds_read_b128 v[216:219], v248 offset:47360
  ds_read_b128 v[220:223], v248 offset:48384
  s_waitcnt lgkmcnt(3)
  v_pk_add_f32 v[192:193], v[192:193], v[208:209]
  v_pk_add_f32 v[194:195], v[194:195], v[210:211]
  v_cvt_pk_bf16_f32 v192, v192, v193
  v_cvt_pk_bf16_f32 v193, v194, v195
  buffer_store_dwordx2 v[192:193], v238, s[56:59], s93 offen offset:0 sc1
  s_waitcnt lgkmcnt(2)
  v_pk_add_f32 v[196:197], v[196:197], v[212:213]
  v_pk_add_f32 v[198:199], v[198:199], v[214:215]
  v_cvt_pk_bf16_f32 v196, v196, v197
  v_cvt_pk_bf16_f32 v197, v198, v199
  buffer_store_dwordx2 v[196:197], v238, s[56:59], s93 offen offset:512 sc1
  s_waitcnt lgkmcnt(1)
  v_pk_add_f32 v[200:201], v[200:201], v[216:217]
  v_pk_add_f32 v[202:203], v[202:203], v[218:219]
  v_cvt_pk_bf16_f32 v200, v200, v201
  v_cvt_pk_bf16_f32 v201, v202, v203
  buffer_store_dwordx2 v[200:201], v238, s[56:59], s93 offen offset:1024 sc1
  s_waitcnt lgkmcnt(0)
  v_pk_add_f32 v[204:205], v[204:205], v[220:221]
  v_pk_add_f32 v[206:207], v[206:207], v[222:223]
  v_cvt_pk_bf16_f32 v204, v204, v205
  v_cvt_pk_bf16_f32 v205, v206, v207
  buffer_store_dwordx2 v[204:205], v238, s[56:59], s93 offen offset:1536 sc1
  s_lshl_b32 s100, s92, 16
  s_waitcnt vmcnt(4)
  s_mov_b32 s83, 0
L_hl:
  v_cmp_ne_u32 vcc, s77, v23
  s_cbranch_vccz L_hl_ok
  s_add_u32 s83, s83, 1
  s_cmp_gt_u32 s83, 30000
  s_cbranch_scc1 L_hl_ok
  global_load_dword v23, v239, s[32:33] sc1
  s_waitcnt vmcnt(0)
  s_branch L_hl
L_hl_ok:
  buffer_load_dwordx4 a[176:179], v241, s[52:55], s100 offen sc1
  s_add_u32 s100, s100, 0x10000
  buffer_load_dwordx4 a[180:183], v241, s[52:55], s100 offen sc1
  s_add_u32 s100, s100, 0x10000
  buffer_load_dwordx4 a[184:187], v241, s[52:55], s100 offen sc1
  s_add_u32 s100, s100, 0x10000
  buffer_load_dwordx4 a[188:191], v241, s[52:55], s100 offen sc1
  s_add_u32 s100, s100, 0x10000
  buffer_load_dwordx4 a[192:195], v241, s[52:55], s100 offen sc1
  s_add_u32 s100, s100, 0x10000
  buffer_load_dwordx4 a[196:199], v241, s[52:55], s100 offen sc1
  s_add_u32 s100, s100, 0x10000
  buffer_load_dwordx4 a[200:203], v241, s[52:55], s100 offen sc1
  s_add_u32 s100, s100, 0x10000
  buffer_load_dwordx4 a[204:207], v241, s[52:55], s100 offen sc1
  s_add_u32 s100, s100, 0x10000
  buffer_load_dwordx4 a[208:211], v241, s[52:55], s100 offen sc1
  s_add_u32 s100, s100, 0x10000
  buffer_load_dwordx4 a[212:215], v241, s[52:55], s100 offen sc1
  s_add_u32 s100, s100, 0x10000
  s_waitcnt vmcnt(9)
  v_mfma_f32_32x32x16_bf16 v[160:175], a[0:3], a[176:179], 0
  buffer_load_dwordx4 a[216:219], v241, s[52:55], s100 offen sc1
  s_add_u32 s100, s100, 0x10000
  v_mfma_f32_32x32x16_bf16 v[176:191], a[4:7], a[176:179], 0
  s_mov_b64 exec, 1
  global_store_dword v243, v3, s[32:33] sc1
  s_mov_b64 exec, -1
  s_waitcnt vmcnt(10)
  v_mfma_f32_32x32x16_bf16 v[160:175], a[8:11], a[180:183], v[160:175]
  buffer_load_dwordx4 a[220:223], v241, s[52:55], s100 offen sc1
  s_add_u32 s100, s100, 0x10000
  v_mfma_f32_32x32x16_bf16 v[176:191], a[12:15], a[180:183], v[176:191]
  s_waitcnt vmcnt(10)
  v_mfma_f32_32x32x16_bf16 v[160:175], a[16:19], a[184:187], v[160:175]
  buffer_load_dwordx4 a[224:227], v241, s[52:55], s100 offen sc1
  s_add_u32 s100, s100, 0x10000
  v_mfma_f32_32x32x16_bf16 v[176:191], a[20:23], a[184:187], v[176:191]
  s_waitcnt vmcnt(10)
  v_mfma_f32_32x32x16_bf16 v[160:175], a[24:27], a[188:191], v[160:175]
  buffer_load_dwordx4 a[228:231], v241, s[52:55], s100 offen sc1
  s_add_u32 s100, s100, 0x10000
  v_mfma_f32_32x32x16_bf16 v[176:191], a[28:31], a[188:191], v[176:191]
  s_waitcnt vmcnt(10)
  v_mfma_f32_32x32x16_bf16 v[160:175], a[32:35], a[192:195], v[160:175]
  buffer_load_dwordx4 a[232:235], v241, s[52:55], s100 offen sc1
  s_add_u32 s100, s100, 0x10000
  v_mfma_f32_32x32x16_bf16 v[176:191], a[36:39], a[192:195], v[176:191]
  s_waitcnt vmcnt(10)
  v_mfma_f32_32x32x16_bf16 v[160:175], a[40:43], a[196:199], v[160:175]
  buffer_load_dwordx4 a[236:239], v241, s[52:55], s100 offen sc1
  s_add_u32 s100, s100, 0x10000
  v_mfma_f32_32x32x16_bf16 v[176:191], a[44:47], a[196:199], v[176:191]
  s_waitcnt vmcnt(10)
  v_mfma_f32_32x32x16_bf16 v[160:175], a[48:51], a[200:203], v[160:175]
  buffer_load_dwordx4 a[240:243], v241, s[52:55], s100 offen sc1
  s_add_u32 s100, s100, 0x10000
  v_mfma_f32_32x32x16_bf16 v[176:191], a[52:55], a[200:203], v[176:191]
  s_waitcnt vmcnt(10)
  v_mfma_f32_32x32x16_bf16 v[160:175], a[56:59], a[204:207], v[160:175]
  buffer_load_dwordx4 a[244:247], v241, s[52:55], s100 offen sc1
  s_add_u32 s100, s100, 0x10000
  v_mfma_f32_32x32x16_bf16 v[176:191], a[60:63], a[204:207], v[176:191]
  s_waitcnt vmcnt(10)
  v_mfma_f32_32x32x16_bf16 v[160:175], a[64:67], a[208:211], v[160:175]
  buffer_load_dwordx4 a[248:251], v241, s[52:55], s100 offen sc1
  s_add_u32 s100, s100, 0x10000
  v_mfma_f32_32x32x16_bf16 v[176:191], a[68:71], a[208:211], v[176:191]
  ds_read_b64_tr_b16 a[104:105], v226 offset:6144
  ds_read_b64_tr_b16 a[106:107], v226 offset:7168
  ds_read_b64_tr_b16 a[108:109], v227 offset:6144
  ds_read_b64_tr_b16 a[110:111], v227 offset:7168
  s_waitcnt vmcnt(10)
  v_mfma_f32_32x32x16_bf16 v[160:175], a[72:75], a[212:215], v[160:175]
  buffer_load_dwordx4 a[252:255], v241, s[52:55], s100 offen sc1
  s_add_u32 s100, s100, 0x10000
  v_mfma_f32_32x32x16_bf16 v[176:191], a[76:79], a[212:215], v[176:191]
  ds_read_b64_tr_b16 a[112:113], v226 offset:8192
  ds_read_b64_tr_b16 a[114:115], v226 offset:9216
  ds_read_b64_tr_b16 a[116:117], v227 offset:8192
  ds_read_b64_tr_b16 a[118:119], v227 offset:9216
  s_waitcnt vmcnt(10)
  v_mfma_f32_32x32x16_bf16 v[160:175], a[80:83], a[216:219], v[160:175]
  buffer_load_dwordx4 v[96:99], v241, s[52:55], s100 offen sc1
  s_add_u32 s100, s100, 0x10000
  v_mfma_f32_32x32x16_bf16 v[176:191], a[84:87], a[216:219], v[176:191]
  ds_read_b64_tr_b16 a[120:121], v224 offset:0
  ds_read_b64_tr_b16 a[122:123], v224 offset:1024
  ds_read_b64_tr_b16 a[124:125], v225 offset:0
  ds_read_b64_tr_b16 a[126:127], v225 offset:1024
  s_waitcnt vmcnt(9)
  v_mfma_f32_32x32x16_bf16 v[160:175], a[88:91], a[220:223], v[160:175]
  buffer_load_dwordx4 v[100:103], v241, s[52:55], s100 offen sc1
  s_lshl_b32 s100, s92, 16
  v_mfma_f32_32x32x16_bf16 v[176:191], a[92:95], a[220:223], v[176:191]
  ds_read_b64_tr_b16 a[128:129], v224 offset:2048
  ds_read_b64_tr_b16 a[130:131], v224 offset:3072
  ds_read_b64_tr_b16 a[132:133], v225 offset:2048
  ds_read_b64_tr_b16 a[134:135], v225 offset:3072
  s_waitcnt vmcnt(9)
  v_mfma_f32_32x32x16_bf16 v[160:175], a[96:99], a[224:227], v[160:175]
  buffer_load_dwordx4 v[32:35], v240, s[52:55], s100 offen sc1
  s_add_u32 s100, s100, 0x10000
  v_mfma_f32_32x32x16_bf16 v[176:191], a[100:103], a[224:227], v[176:191]
  ds_read_b64_tr_b16 a[136:137], v224 offset:4096
  ds_read_b64_tr_b16 a[138:139], v224 offset:5120
  ds_read_b64_tr_b16 a[140:141], v225 offset:4096
  ds_read_b64_tr_b16 a[142:143], v225 offset:5120
  s_waitcnt vmcnt(9) lgkmcnt(12)
  v_mfma_f32_32x32x16_bf16 v[160:175], a[104:107], a[228:231], v[160:175]
  buffer_load_dwordx4 v[36:39], v240, s[52:55], s100 offen sc1
  s_add_u32 s100, s100, 0x10000
  v_mfma_f32_32x32x16_bf16 v[176:191], a[108:111], a[228:231], v[176:191]
  ds_read_b64_tr_b16 a[144:145], v224 offset:6144
  ds_read_b64_tr_b16 a[146:147], v224 offset:7168
  ds_read_b64_tr_b16 a[148:149], v225 offset:6144
  ds_read_b64_tr_b16 a[150:151], v225 offset:7168
  s_waitcnt vmcnt(9) lgkmcnt(12)
  v_mfma_f32_32x32x16_bf16 v[160:175], a[112:115], a[232:235], v[160:175]
  buffer_load_dwordx4 v[40:43], v240, s[52:55], s100 offen sc1
  s_add_u32 s100, s100, 0x10000
  v_mfma_f32_32x32x16_bf16 v[176:191], a[116:119], a[232:235], v[176:191]
  ds_read_b64_tr_b16 a[152:153], v224 offset:41216
  ds_read_b64_tr_b16 a[154:155], v224 offset:42240
  ds_read_b64_tr_b16 a[156:157], v225 offset:41216
  ds_read_b64_tr_b16 a[158:159], v225 offset:42240
  s_waitcnt vmcnt(9) lgkmcnt(12)
  v_mfma_f32_32x32x16_bf16 v[160:175], a[120:123], a[236:239], v[160:175]
  buffer_load_dwordx4 v[44:47], v240, s[52:55], s100 offen sc1
  s_add_u32 s100, s100, 0x10000
  v_mfma_f32_32x32x16_bf16 v[176:191], a[124:127], a[236:239], v[176:191]
  ds_read_b64_tr_b16 a[160:161], v224 offset:43264
  ds_read_b64_tr_b16 a[162:163], v224 offset:44288
  ds_read_b64_tr_b16 a[164:165], v225 offset:43264
  ds_read_b64_tr_b16 a[166:167], v225 offset:44288
  s_waitcnt vmcnt(9) lgkmcnt(12)
  v_mfma_f32_32x32x16_bf16 v[160:175], a[128:131], a[240:243], v[160:175]
  buffer_load_dwordx4 v[48:51], v240, s[52:55], s100 offen sc1
  s_add_u32 s100, s100, 0x10000
  v_mfma_f32_32x32x16_bf16 v[176:191], a[132:135], a[240:243], v[176:191]
  ds_read_b64_tr_b16 a[168:169], v224 offset:8192
  ds_read_b64_tr_b16 a[170:171], v224 offset:9216
  ds_read_b64_tr_b16 a[172:173], v225 offset:8192
  ds_read_b64_tr_b16 a[174:175], v225 offset:9216
  s_waitcnt vmcnt(9) lgkmcnt(12)
  v_mfma_f32_32x32x16_bf16 v[160:175], a[136:139], a[244:247], v[160:175]
  buffer_load_dwordx4 v[52:55], v240, s[52:55], s100 offen sc1
  s_add_u32 s100, s100, 0x10000
  v_mfma_f32_32x32x16_bf16 v[176:191], a[140:143], a[244:247], v[176:191]
  s_waitcnt vmcnt(9) lgkmcnt(12)
  v_mfma_f32_32x32x16_bf16 v[160:175], a[144:147], a[248:251], v[160:175]
  buffer_load_dwordx4 v[56:59], v240, s[52:55], s100 offen sc1
  s_add_u32 s100, s100, 0x10000
  v_mfma_f32_32x32x16_bf16 v[176:191], a[148:151], a[248:251], v[176:191]
  s_waitcnt vmcnt(9) lgkmcnt(8)
  v_mfma_f32_32x32x16_bf16 v[160:175], a[152:155], a[252:255], v[160:175]
  buffer_load_dwordx4 v[60:63], v240, s[52:55], s100 offen sc1
  s_add_u32 s100, s100, 0x10000
  v_mfma_f32_32x32x16_bf16 v[176:191], a[156:159], a[252:255], v[176:191]
  s_waitcnt vmcnt(9) lgkmcnt(4)
  v_mfma_f32_32x32x16_bf16 v[160:175], a[160:163], v[96:99], v[160:175]
  buffer_load_dwordx4 v[64:67], v240, s[52:55], s100 offen sc1
  s_add_u32 s100, s100, 0x10000
  v_mfma_f32_32x32x16_bf16 v[176:191], a[164:167], v[96:99], v[176:191]
  s_waitcnt vmcnt(9) lgkmcnt(0)
  v_mfma_f32_32x32x16_bf16 v[160:175], a[168:171], v[100:103], v[160:175]
  buffer_load_dwordx4 v[68:71], v240, s[52:55], s100 offen sc1
  s_add_u32 s100, s100, 0x10000
  v_mfma_f32_32x32x16_bf16 v[176:191], a[172:175], v[100:103], v[176:191]
  s_waitcnt vmcnt(9)
  buffer_load_dwordx4 v[72:75], v240, s[52:55], s100 offen sc1
  s_add_u32 s100, s100, 0x10000
  v_mfma_f32_32x32x16_bf16 v[144:159], a[4:7], v[32:35], 0
  s_waitcnt vmcnt(9)
  buffer_load_dwordx4 v[76:79], v240, s[52:55], s100 offen sc1
  s_add_u32 s100, s100, 0x10000
  v_mfma_f32_32x32x16_bf16 v[144:159], a[12:15], v[36:39], v[144:159]
  s_waitcnt vmcnt(9)
  buffer_load_dwordx4 v[80:83], v240, s[52:55], s100 offen sc1
  s_add_u32 s100, s100, 0x10000
  v_mfma_f32_32x32x16_bf16 v[144:159], a[20:23], v[40:43], v[144:159]
  ds_write_b128 v251, v[160:163] offset:0
  s_waitcnt vmcnt(9)
  buffer_load_dwordx4 v[84:87], v240, s[52:55], s100 offen sc1
  s_add_u32 s100, s100, 0x10000
  v_mfma_f32_32x32x16_bf16 v[144:159], a[28:31], v[44:47], v[144:159]
  ds_write_b128 v251, v[164:167] offset:1024
  s_waitcnt vmcnt(9)
  buffer_load_dwordx4 v[88:91], v240, s[52:55], s100 offen sc1
  s_add_u32 s100, s100, 0x10000
  v_mfma_f32_32x32x16_bf16 v[144:159], a[36:39], v[48:51], v[144:159]
  ds_write_b128 v251, v[168:171] offset:2048
  s_waitcnt vmcnt(9)
  buffer_load_dwordx4 v[92:95], v240, s[52:55], s100 offen sc1
  s_add_u32 s100, s100, 0x10000
  v_mfma_f32_32x32x16_bf16 v[144:159], a[44:47], v[52:55], v[144:159]
  ds_write_b128 v251, v[172:175] offset:3072
  global_load_dword v12, v242, s[32:33] sc1
  global_load_dword v23, v237, s[32:33] sc1
  s_waitcnt vmcnt(11)
  buffer_load_dwordx4 v[104:107], v240, s[52:55], s100 offen sc1
  s_add_u32 s100, s100, 0x10000
  v_mfma_f32_32x32x16_bf16 v[144:159], a[52:55], v[56:59], v[144:159]
  ds_write_b128 v251, v[176:179] offset:4096
  s_waitcnt vmcnt(11)
  buffer_load_dwordx4 v[108:111], v240, s[52:55], s100 offen sc1
  s_add_u32 s100, s100, 0x10000
  v_mfma_f32_32x32x16_bf16 v[144:159], a[60:63], v[60:63], v[144:159]
  ds_write_b128 v251, v[180:183] offset:5120
  s_waitcnt vmcnt(11)
  v_mfma_f32_32x32x16_bf16 v[128:143], a[0:3], v[32:35], 0
  buffer_load_dwordx4 v[112:115], v240, s[52:55], s100 offen sc1
  s_add_u32 s100, s100, 0x10000
  v_mfma_f32_32x32x16_bf16 v[144:159], a[68:71], v[64:67], v[144:159]
  ds_write_b128 v251, v[184:187] offset:6144
  s_waitcnt vmcnt(11)
  v_mfma_f32_32x32x16_bf16 v[128:143], a[8:11], v[36:39], v[128:143]
  buffer_load_dwordx4 v[116:119], v240, s[52:55], s100 offen sc1
  s_add_u32 s100, s100, 0x10000
  v_mfma_f32_32x32x16_bf16 v[144:159], a[76:79], v[68:71], v[144:159]
  ds_write_b128 v251, v[188:191] offset:7168
  s_waitcnt vmcnt(11)
  v_mfma_f32_32x32x16_bf16 v[128:143], a[16:19], v[40:43], v[128:143]
  buffer_load_dwordx4 v[120:123], v240, s[52:55], s100 offen sc1
  s_add_u32 s100, s100, 0x10000
  v_mfma_f32_32x32x16_bf16 v[144:159], a[84:87], v[72:75], v[144:159]
  s_waitcnt vmcnt(11)
  v_mfma_f32_32x32x16_bf16 v[128:143], a[24:27], v[44:47], v[128:143]
  buffer_load_dwordx4 v[124:127], v240, s[52:55], s100 offen sc1
  s_lshl_b32 s100, s92, 16
  v_mfma_f32_32x32x16_bf16 v[144:159], a[92:95], v[76:79], v[144:159]
  s_waitcnt vmcnt(11)
  v_mfma_f32_32x32x16_bf16 v[128:143], a[32:35], v[48:51], v[128:143]
  v_mfma_f32_32x32x16_bf16 v[144:159], a[100:103], v[80:83], v[144:159]
  s_waitcnt vmcnt(10)
  v_mfma_f32_32x32x16_bf16 v[128:143], a[40:43], v[52:55], v[128:143]
  v_mfma_f32_32x32x16_bf16 v[144:159], a[108:111], v[84:87], v[144:159]
  s_waitcnt vmcnt(9)
  v_mfma_f32_32x32x16_bf16 v[128:143], a[48:51], v[56:59], v[128:143]
  v_mfma_f32_32x32x16_bf16 v[144:159], a[116:119], v[88:91], v[144:159]
  s_waitcnt vmcnt(6)
  v_cmp_ne_u32 vcc, s77, v23
  s_cbranch_vccnz L_yslow
L_yret:
  buffer_load_dwordx4 v[208:211], v245, s[56:59], 0 offen sc1
  s_mov_b32 s80, 0x10000
  buffer_load_dwordx4 v[212:215], v245, s[56:59], s80 offen sc1
  s_waitcnt vmcnt(10)
  v_mfma_f32_32x32x16_bf16 v[128:143], a[56:59], v[60:63], v[128:143]
  v_mfma_f32_32x32x16_bf16 v[144:159], a[124:127], v[92:95], v[144:159]
  s_waitcnt vmcnt(7)
  v_mfma_f32_32x32x16_bf16 v[128:143], a[64:67], v[64:67], v[128:143]
  v_mfma_f32_32x32x16_bf16 v[144:159], a[132:135], v[104:107], v[144:159]
  s_waitcnt vmcnt(6)
  v_mfma_f32_32x32x16_bf16 v[128:143], a[72:75], v[68:71], v[128:143]
  v_mfma_f32_32x32x16_bf16 v[144:159], a[140:143], v[108:111], v[144:159]
  s_waitcnt vmcnt(5)
  v_mfma_f32_32x32x16_bf16 v[128:143], a[80:83], v[72:75], v[128:143]
  v_mfma_f32_32x32x16_bf16 v[144:159], a[148:151], v[112:115], v[144:159]
  s_waitcnt vmcnt(4)
  v_mfma_f32_32x32x16_bf16 v[128:143], a[88:91], v[76:79], v[128:143]
  v_mfma_f32_32x32x16_bf16 v[144:159], a[156:159], v[116:119], v[144:159]
  s_waitcnt vmcnt(3)
  v_mfma_f32_32x32x16_bf16 v[128:143], a[96:99], v[80:83], v[128:143]
  v_mfma_f32_32x32x16_bf16 v[144:159], a[164:167], v[120:123], v[144:159]
  s_waitcnt vmcnt(2)
  v_mfma_f32_32x32x16_bf16 v[128:143], a[104:107], v[84:87], v[128:143]
  v_mfma_f32_32x32x16_bf16 v[144:159], a[172:175], v[124:127], v[144:159]
  s_waitcnt vmcnt(0)
  ds_write_b128 v246, v[208:211]
  ds_write_b128 v246, v[212:215] offset:1024
  s_waitcnt lgkmcnt(0)
  v_mfma_f32_32x32x16_bf16 v[128:143], a[112:115], v[88:91], v[128:143]
  ds_read_b64_tr_b16 v[24:25], v247 offset:0
  ds_read_b64_tr_b16 v[26:27], v247 offset:512
  ds_read_b64_tr_b16 v[28:29], v247 offset:1024
  ds_read_b64_tr_b16 v[30:31], v247 offset:1536
  v_mfma_f32_32x32x16_bf16 v[128:143], a[120:123], v[92:95], v[128:143]
  s_nop 4
  ds_write_b128 v251, v[144:147] offset:41216
  ds_write_b128 v251, v[148:151] offset:42240
  v_mfma_f32_32x32x16_bf16 v[128:143], a[128:131], v[104:107], v[128:143]
  ds_write_b128 v251, v[152:155] offset:43264
  ds_write_b128 v251, v[156:159] offset:44288
  v_mfma_f32_32x32x16_bf16 v[128:143], a[136:139], v[108:111], v[128:143]
  s_waitcnt lgkmcnt(4)
  v_lshlrev_b32 v208, 16, v24
  v_and_b32 v209, 0xffff0000, v24
  v_lshlrev_b32 v210, 16, v25
  v_and_b32 v211, 0xffff0000, v25
  v_lshlrev_b32 v212, 16, v26
  v_and_b32 v213, 0xffff0000, v26
  v_lshlrev_b32 v214, 16, v27
  v_and_b32 v215, 0xffff0000, v27
  v_mfma_f32_32x32x16_bf16 v[128:143], a[144:147], v[112:115], v[128:143]
  v_lshlrev_b32 v216, 16, v28
  v_and_b32 v217, 0xffff0000, v28
  v_lshlrev_b32 v218, 16, v29
  v_and_b32 v219, 0xffff0000, v29
  v_lshlrev_b32 v220, 16, v30
  v_and_b32 v221, 0xffff0000, v30
  v_lshlrev_b32 v222, 16, v31
  v_and_b32 v223, 0xffff0000, v31
  s_waitcnt lgkmcnt(0)
  s_barrier
  v_mfma_f32_32x32x16_bf16 v[128:143], a[152:155], v[116:119], v[128:143]
  ds_read_b128 v[144:147], v248 offset:41216
  ds_read_b128 v[160:163], v249 offset:0
  ds_read_b128 v[176:179], v250 offset:4096
  ds_read_b128 v[148:151], v248 offset:42240
  ds_read_b128 v[164:167], v249 offset:1024
  ds_read_b128 v[180:183], v250 offset:5120
  v_mfma_f32_32x32x16_bf16 v[128:143], a[160:163], v[120:123], v[128:143]
  ds_read_b128 v[152:155], v248 offset:43264
  ds_read_b128 v[168:171], v249 offset:2048
  ds_read_b128 v[184:187], v250 offset:6144
  ds_read_b128 v[156:159], v248 offset:44288
  ds_read_b128 v[172:175], v249 offset:3072
  ds_read_b128 v[188:191], v250 offset:7168
  v_mfma_f32_32x32x16_bf16 v[128:143], a[168:171], v[124:127], v[128:143]
  s_nop 10
  s_waitcnt lgkmcnt(9)
  v_pk_add_f32 v[128:129], v[128:129], v[144:145]
  v_pk_add_f32 v[160:161], v[160:161], v[176:177]
  v_pk_add_f32 v[130:131], v[130:131], v[146:147]
  v_pk_add_f32 v[128:129], v[128:129], v[160:161]
  v_pk_add_f32 v[162:163], v[162:163], v[178:179]
  v_pk_add_f32 v[208:209], v[208:209], v[128:129] neg_lo:[0,1] neg_hi:[0,1]
  v_pk_add_f32 v[130:131], v[130:131], v[162:163]
  v_pk_fma_f32 v[208:209], v[208:209], v[12:13], v[128:129] op_sel_hi:[1,0,1]
  v_pk_add_f32 v[210:211], v[210:211], v[130:131] neg_lo:[0,1] neg_hi:[0,1]
  v_cvt_pk_bf16_f32 v48, v208, v209
  v_pk_fma_f32 v[210:211], v[210:211], v[12:13], v[130:131] op_sel_hi:[1,0,1]
  v_cvt_pk_bf16_f32 v49, v210, v211
  s_waitcnt lgkmcnt(6)
  v_pk_add_f32 v[132:133], v[132:133], v[148:149]
  v_pk_add_f32 v[164:165], v[164:165], v[180:181]
  v_pk_add_f32 v[134:135], v[134:135], v[150:151]
  v_pk_add_f32 v[132:133], v[132:133], v[164:165]
  v_pk_add_f32 v[166:167], v[166:167], v[182:183]
  v_pk_add_f32 v[212:213], v[212:213], v[132:133] neg_lo:[0,1] neg_hi:[0,1]
  v_pk_add_f32 v[134:135], v[134:135], v[166:167]
  v_pk_fma_f32 v[212:213], v[212:213], v[12:13], v[132:133] op_sel_hi:[1,0,1]
  v_pk_add_f32 v[214:215], v[214:215], v[134:135] neg_lo:[0,1] neg_hi:[0,1]
  v_cvt_pk_bf16_f32 v50, v212, v213
  v_pk_fma_f32 v[214:215], v[214:215], v[12:13], v[134:135] op_sel_hi:[1,0,1]
  v_cvt_pk_bf16_f32 v51, v214, v215
  s_nop 1
  v_permlane32_swap_b32 v48, v50
  v_permlane32_swap_b32 v49, v51
  buffer_store_dwordx4 v[48:51], v244, s[60:63], 0 offen offset:0
  s_waitcnt lgkmcnt(3)
  v_pk_add_f32 v[136:137], v[136:137], v[152:153]
  v_pk_add_f32 v[168:169], v[168:169], v[184:185]
  v_pk_add_f32 v[138:139], v[138:139], v[154:155]
  v_pk_add_f32 v[136:137], v[136:137], v[168:169]
  v_pk_add_f32 v[170:171], v[170:171], v[186:187]
  v_pk_add_f32 v[216:217], v[216:217], v[136:137] neg_lo:[0,1] neg_hi:[0,1]
  v_pk_add_f32 v[138:139], v[138:139], v[170:171]
  v_pk_fma_f32 v[216:217], v[216:217], v[12:13], v[136:137] op_sel_hi:[1,0,1]
  v_pk_add_f32 v[218:219], v[218:219], v[138:139] neg_lo:[0,1] neg_hi:[0,1]
  v_cvt_pk_bf16_f32 v52, v216, v217
  v_pk_fma_f32 v[218:219], v[218:219], v[12:13], v[138:139] op_sel_hi:[1,0,1]
  v_cvt_pk_bf16_f32 v53, v218, v219
  s_waitcnt lgkmcnt(0)
  v_pk_add_f32 v[140:141], v[140:141], v[156:157]
  v_pk_add_f32 v[172:173], v[172:173], v[188:189]
  v_pk_add_f32 v[142:143], v[142:143], v[158:159]
  v_pk_add_f32 v[140:141], v[140:141], v[172:173]
  v_pk_add_f32 v[174:175], v[174:175], v[190:191]
  v_pk_add_f32 v[220:221], v[220:221], v[140:141] neg_lo:[0,1] neg_hi:[0,1]
  v_pk_add_f32 v[142:143], v[142:143], v[174:175]
  v_pk_fma_f32 v[220:221], v[220:221], v[12:13], v[140:141] op_sel_hi:[1,0,1]
  v_pk_add_f32 v[222:223], v[222:223], v[142:143] neg_lo:[0,1] neg_hi:[0,1]
  v_cvt_pk_bf16_f32 v54, v220, v221
  v_pk_fma_f32 v[222:223], v[222:223], v[12:13], v[142:143] op_sel_hi:[1,0,1]
  v_cvt_pk_bf16_f32 v55, v222, v223
  s_nop 1
  v_permlane32_swap_b32 v52, v54
  v_permlane32_swap_b32 v53, v55
  buffer_store_dwordx4 v[52:55], v244, s[60:63], 0 offen offset:32
L_end:
  s_endpgm
L_yslow:
  s_mov_b32 s83, 0
L_ychk:
  v_cmp_ne_u32 vcc, s77, v23
  s_cbranch_vccz L_ychk_ok
  s_add_u32 s83, s83, 1
  s_cmp_gt_u32 s83, 30000
  s_cbranch_scc1 L_ychk_ok
  global_load_dword v23, v237, s[32:33] sc1
  s_waitcnt vmcnt(0)
  s_branch L_ychk
L_ychk_ok:
  s_branch L_yret
L_g1w12:
  s_waitcnt vmcnt(12)
  s_branch L_g1wret
L_g1x:
  v_mov_b32 v3, s77
  s_mov_b64 exec, 1
  global_store_dword v29, v3, s[32:33] sc1
  s_mov_b64 exec, -1
  s_branch L_g1ret
L_epoch:
  s_mov_b32 s83, 0
  v_lshlrev_b32 v2, 4, v1
  v_mov_b32 v4, 0x00a30000
  s_mov_b32 s80, 0x00a40000
L_epspin:
  buffer_load_dwordx4 v[96:99], v2, s[56:59], s80 offen sc1
  s_waitcnt vmcnt(0)
  v_min3_u32 v24, v96, v97, v98
  v_max3_u32 v25, v96, v97, v98
  v_min_u32 v24, v24, v99
  v_max_u32 v25, v25, v99
  v_cmp_ne_u32 vcc, s77, v24
  v_cmp_ne_u32 s[98:99], s77, v25
  s_or_b64 vcc, vcc, s[98:99]
  s_cbranch_scc0 L_epok
  s_add_u32 s83, s83, 1
  s_cmp_lt_u32 s83, 30000
  s_cbranch_scc1 L_epspin
L_epok:
  s_mov_b64 exec, 1
  global_store_dword v4, v3, s[32:33] sc1
  s_mov_b64 exec, -1
  s_branch L_epret
L_utslow:
  global_load_dword v23, v24, s[32:33] sc1
  s_waitcnt vmcnt(0)
  s_mov_b32 s83, 0
L_uchk:
  v_cmp_ne_u32 vcc, s77, v23
  s_cbranch_vccz L_uchk_ok
  s_add_u32 s83, s83, 1
  s_cmp_gt_u32 s83, 30000
  s_cbranch_scc1 L_uchk_ok
  global_load_dword v23, v24, s[32:33] sc1
  s_waitcnt vmcnt(0)
  s_branch L_uchk
L_uchk_ok:
  v_lshlrev_b32 v2, 4, v0
  s_add_u32 s80, s94, 4096
  buffer_load_dwordx4 v[24:27], v2, s[56:59], s94 offen sc1
  buffer_load_dwordx4 v[28:31], v2, s[56:59], s80 offen sc1
  s_waitcnt vmcnt(0)
  ds_write_b128 v252, v[24:27]
  ds_write_b128 v252, v[28:31] offset:4608
  s_branch L_utret
L_gld0:
  s_mul_i32 s81, s35, 688
  v_add_u32 v2, s81, v0
  v_lshlrev_b32 v2, 7, v2
  global_load_dword v8, v2, s[24:25]
  v_add_u32 v2, 32768, v2
  global_load_dword v8, v2, s[24:25]
  v_add_u32 v2, 22528, v2
  global_load_dword v8, v2, s[24:25]
  s_waitcnt vmcnt(3)
  s_mul_i32 s83, s34, 192
  s_mul_i32 s84, s36, 192
  v_add_u32 v36, s83, v1
  v_mul_u32_u24 v37, 43691, v36
  v_lshrrev_b32 v37, 19, v37
  v_mul_u32_u24 v38, 12, v37
  v_sub_u32 v38, v36, v38
  v_mul_u32_u24 v37, 2752, v37
  v_lshl_add_u32 v37, v38, 4, v37
  v_add_u32 v14, s84, v37
  v_add_u32 v5, s84, v37
  s_add_u32 s83, s83, 64
  s_sub_u32 s84, s84, 1024
  v_add_u32 v36, s83, v1
  v_mul_u32_u24 v37, 43691, v36
  v_lshrrev_b32 v37, 19, v37
  v_mul_u32_u24 v38, 12, v37
  v_sub_u32 v38, v36, v38
  v_mul_u32_u24 v37, 2752, v37
  v_lshl_add_u32 v37, v38, 4, v37
  v_add_u32 v15, s84, v37
  v_add_u32 v6, s84, v37
  s_add_u32 s83, s83, 64
  s_sub_u32 s84, s84, 1024
  v_add_u32 v36, s83, v1
  v_mul_u32_u24 v37, 43691, v36
  v_lshrrev_b32 v37, 19, v37
  v_mul_u32_u24 v38, 12, v37
  v_sub_u32 v38, v36, v38
  v_mul_u32_u24 v37, 2752, v37
  v_lshl_add_u32 v37, v38, 4, v37
  v_add_u32 v16, s84, v37
  v_add_u32 v7, s84, v37
  s_mul_i32 s65, s79, 176128
  s_mul_i32 s73, s34, 3072
  s_add_u32 s74, s73, 28704
  s_add_u32 s73, s73, 16384
  s_mov_b64 s[44:45], s[20:21]
  s_mov_b32 s46, 1409024
  s_mov_b32 s47, 0x20000
  s_mov_b64 s[48:49], s[22:23]
  s_mov_b32 s50, 1409024
  s_mov_b32 s51, 0x20000
  s_mov_b32 s66, 128
  s_mov_b32 s101, 1024
  s_mov_b32 s68, 176128
  s_mov_b32 s69, 1409024
  v_mov_b32 v9, 0
  s_branch L_setup
L_gjoin:
  s_mov_b64 s[44:45], s[26:27]
  s_mov_b32 s46, 1024
  s_lshl_b32 s80, s34, 10
  s_add_u32 m0, s80, 131072
  v_lshlrev_b32 v2, 4, v1
  buffer_load_dwordx4 v2, s[44:47], 0 offen lds
  s_mov_b32 s39, 0
L_gld1:
  s_add_u32 s82, s39, s79
  s_and_b32 s82, s82, 7
  s_lshl_b32 s81, s82, 14
  s_add_u32 m0, s81, s72
  s_lshl_b32 s81, s82, 7
  buffer_load_dwordx4 v10, s[40:43], s81 offen offset:0 lds
  buffer_load_dwordx4 v11, s[40:43], s81 offen offset:1024 lds
  buffer_load_dwordx4 v12, s[40:43], s81 offen offset:2048 lds
  buffer_load_dwordx4 v13, s[40:43], s81 offen offset:3072 lds
  s_add_u32 s39, s39, 1
  s_mov_b32 s46, 1409024
  v_and_b32 v32, 31, v1
  v_lshrrev_b32 v33, 5, v1
  v_bfe_u32 v44, v1, 1, 3
  v_xor_b32 v44, v44, v33
  v_lshlrev_b32 v44, 4, v44
  v_lshl_add_u32 v44, v32, 7, v44
  v_add_u32 v44, s72, v44
  v_xor_b32 v45, 32, v44
  v_xor_b32 v46, 64, v44
  v_xor_b32 v47, 96, v44
  s_add_u32 s80, s80, 131072
  v_lshl_add_u32 v40, v33, 4, s80
  s_lshl_b32 s80, s35, 2
  s_add_u32 s80, s80, s34
  s_lshl_b32 s80, s80, 7
  s_add_u32 s80, s80, 0x00a00000
  v_lshl_add_u32 v42, v32, 2, s80
  s_lshl_b32 s80, s79, 14
  s_sub_u32 s80, s80, 67328
  v_add_u32 v62, s80, v62
  v_add_u32 v63, s80, v63
  v_add_u32 v64, s80, v64
  v_add_u32 v65, s80, v65
  s_waitcnt vmcnt(0)
  s_barrier
  ds_read_b64_tr_b16 v[98:99], v62 offset:0
  ds_read_b64_tr_b16 v[100:101], v63 offset:512
  ds_read_b64_tr_b16 v[102:103], v64 offset:0
  ds_read_b64_tr_b16 v[104:105], v65 offset:512
  s_mov_b32 s80, 32768
  s_waitcnt lgkmcnt(2)
  buffer_store_dwordx4 v[98:101], v68, s[56:59], 0 offen sc1
  s_waitcnt lgkmcnt(0)
  buffer_store_dwordx4 v[102:105], v68, s[56:59], s80 offen sc1
L_gld2:
  s_add_u32 s82, s39, s79
  s_and_b32 s82, s82, 7
  s_lshl_b32 s81, s82, 14
  s_add_u32 m0, s81, s72
  s_lshl_b32 s81, s82, 7
  buffer_load_dwordx4 v10, s[40:43], s81 offen offset:0 lds
  buffer_load_dwordx4 v11, s[40:43], s81 offen offset:1024 lds
  buffer_load_dwordx4 v12, s[40:43], s81 offen offset:2048 lds
  buffer_load_dwordx4 v13, s[40:43], s81 offen offset:3072 lds
  s_add_u32 s39, s39, 1
  s_cmp_lt_u32 s39, 8
  s_cbranch_scc1 L_gld2
  s_waitcnt vmcnt(28)
  s_barrier
  s_cmp_lg_u32 s34, 0
  s_cbranch_scc1 L_gnf
  v_mov_b32 v3, s77
  s_mov_b64 exec, 1
  global_store_dword v29, v3, s[32:33] sc1
  s_mov_b64 exec, -1
L_gnf:
  s_mov_b32 s39, 0
  s_waitcnt vmcnt(0)
  ds_read_b128 v[48:51], v44
  ds_read_b128 v[144:147], v40 offset:0
  ds_read_b128 v[52:55], v45
  ds_read_b128 v[148:151], v40 offset:32
  ds_read_b128 v[56:59], v46
  ds_read_b128 v[152:155], v40 offset:64
  ds_read_b128 v[60:63], v47
  ds_read_b128 v[156:159], v40 offset:96
  v_add_u32 v44, 16384, v44
  v_add_u32 v45, 16384, v45
  v_add_u32 v46, 16384, v46
  v_add_u32 v47, 16384, v47
  v_add_u32 v40, 128, v40
L_glp:
  ds_read_b128 v[160:163], v44
  ds_read_b128 v[176:179], v40 offset:0
  ds_read_b128 v[164:167], v45
  ds_read_b128 v[180:183], v40 offset:32
  ds_read_b128 v[168:171], v46
  ds_read_b128 v[184:187], v40 offset:64
  ds_read_b128 v[172:175], v47
  ds_read_b128 v[188:191], v40 offset:96
  v_add_u32 v44, 16384, v44
  v_add_u32 v45, 16384, v45
  v_add_u32 v46, 16384, v46
  v_add_u32 v47, 16384, v47
  v_add_u32 v40, 128, v40
  s_waitcnt lgkmcnt(8)
  v_mfma_f32_32x32x16_bf16 v[128:143], v[144:147], v[48:51], v[128:143]
  v_mfma_f32_32x32x16_bf16 v[128:143], v[148:151], v[52:55], v[128:143]
  v_mfma_f32_32x32x16_bf16 v[128:143], v[152:155], v[56:59], v[128:143]
  v_mfma_f32_32x32x16_bf16 v[128:143], v[156:159], v[60:63], v[128:143]
  ds_read_b128 v[48:51], v44
  ds_read_b128 v[144:147], v40 offset:0
  ds_read_b128 v[52:55], v45
  ds_read_b128 v[148:151], v40 offset:32
  ds_read_b128 v[56:59], v46
  ds_read_b128 v[152:155], v40 offset:64
  ds_read_b128 v[60:63], v47
  ds_read_b128 v[156:159], v40 offset:96
  v_add_u32 v44, 16384, v44
  v_add_u32 v45, 16384, v45
  v_add_u32 v46, 16384, v46
  v_add_u32 v47, 16384, v47
  v_add_u32 v40, 128, v40
  s_waitcnt lgkmcnt(8)
  v_mfma_f32_32x32x16_bf16 v[128:143], v[176:179], v[160:163], v[128:143]
  v_mfma_f32_32x32x16_bf16 v[128:143], v[180:183], v[164:167], v[128:143]
  v_mfma_f32_32x32x16_bf16 v[128:143], v[184:187], v[168:171], v[128:143]
  v_mfma_f32_32x32x16_bf16 v[128:143], v[188:191], v[172:175], v[128:143]
  s_add_u32 s39, s39, 1
  s_cmp_lt_u32 s39, 4
  s_cbranch_scc1 L_glp
  s_nop 7
  s_nop 7
  v_cvt_pk_bf16_f32 v43, v128, v128
  v_lshlrev_b32 v43, 16, v43
  v_mul_f32 v43, 0xbfb8aa3b, v43
  v_exp_f32 v43, v43
  s_nop 0
  v_add_f32 v43, 1.0, v43
  v_rcp_f32 v43, v43
  s_nop 0
  v_cvt_pk_bf16_f32 v43, v43, v43
  v_lshlrev_b32 v43, 16, v43
  s_mov_b32 exec_hi, 0
  buffer_store_dword v43, v42, s[56:59], 0 offen sc1
  s_mov_b32 exec_hi, -1
  global_load_dword v23, v24, s[32:33] sc1
  s_waitcnt lgkmcnt(0)
  s_barrier
  s_mov_b32 s14, 0
  s_add_u32 m0, s95, 26112
  s_nop 0
  buffer_load_dwordx4 v122, s[16:19], s14 offen lds
  buffer_load_dwordx4 v123, s[16:19], s14 offen offset:1024 lds
  buffer_load_dwordx4 v124, s[16:19], s14 offen offset:2048 lds
  buffer_load_dwordx4 v125, s[16:19], s14 offen offset:3072 lds
  s_mov_b32 s15, 32768
  s_add_u32 m0, s95, 30208
  s_nop 0
  buffer_load_dwordx4 v122, s[16:19], s15 offen lds
  buffer_load_dwordx4 v123, s[16:19], s15 offen offset:1024 lds
  buffer_load_dwordx4 v124, s[16:19], s15 offen offset:2048 lds
  s_branch L_exp
L_gexpret:
  s_waitcnt vmcnt(7)
  s_mov_b32 s83, 0
L_guf:
  v_cmp_ne_u32 vcc, s77, v23
  s_cbranch_vccz L_guf_ok
  s_add_u32 s83, s83, 1
  s_cmp_gt_u32 s83, 30000
  s_cbranch_scc1 L_guf_ok
  global_load_dword v23, v24, s[32:33] sc1
  s_waitcnt vmcnt(0)
  s_branch L_guf
L_guf_ok:
  v_lshlrev_b32 v2, 4, v0
  s_add_u32 s80, s94, 4096
  buffer_load_dwordx4 v[24:27], v2, s[56:59], s94 offen sc1
  buffer_load_dwordx4 v[28:31], v2, s[56:59], s80 offen sc1
  s_mov_b32 s3, 57344
  s_add_u32 m0, s95, 33280
  s_nop 0
  buffer_load_dwordx4 v122, s[16:19], s3 offen lds
  buffer_load_dwordx4 v123, s[16:19], s3 offen offset:1024 lds
  buffer_load_dwordx4 v124, s[16:19], s3 offen offset:2048 lds
  s_mov_b32 s14, 81920
  s_add_u32 m0, s95, 67328
  s_nop 0
  buffer_load_dwordx4 v122, s[16:19], s14 offen lds
  buffer_load_dwordx4 v123, s[16:19], s14 offen offset:1024 lds
  buffer_load_dwordx4 v124, s[16:19], s14 offen offset:2048 lds
  buffer_load_dwordx4 v125, s[16:19], s14 offen offset:3072 lds
  s_mov_b32 s15, 114688
  s_add_u32 m0, s95, 71424
  s_nop 0
  buffer_load_dwordx4 v122, s[16:19], s15 offen lds
  buffer_load_dwordx4 v123, s[16:19], s15 offen offset:1024 lds
  buffer_load_dwordx4 v124, s[16:19], s15 offen offset:2048 lds
  s_mov_b32 s3, 139264
  s_add_u32 m0, s95, 74496
  s_nop 0
  buffer_load_dwordx4 v122, s[16:19], s3 offen lds
  buffer_load_dwordx4 v123, s[16:19], s3 offen offset:1024 lds
  buffer_load_dwordx4 v124, s[16:19], s3 offen offset:2048 lds
  s_mov_b32 s14, 163840
  s_add_u32 m0, s95, 108544
  s_nop 0
  buffer_load_dwordx4 v122, s[16:19], s14 offen lds
  buffer_load_dwordx4 v123, s[16:19], s14 offen offset:1024 lds
  buffer_load_dwordx4 v124, s[16:19], s14 offen offset:2048 lds
  buffer_load_dwordx4 v125, s[16:19], s14 offen offset:3072 lds
  s_mov_b32 s15, 196608
  s_add_u32 m0, s95, 112640
  s_nop 0
  buffer_load_dwordx4 v122, s[16:19], s15 offen lds
  buffer_load_dwordx4 v123, s[16:19], s15 offen offset:1024 lds
  buffer_load_dwordx4 v124, s[16:19], s15 offen offset:2048 lds
  s_mov_b32 s3, 221184
  s_add_u32 m0, s95, 115712
  s_nop 0
  buffer_load_dwordx4 v122, s[16:19], s3 offen lds
  buffer_load_dwordx4 v123, s[16:19], s3 offen offset:1024 lds
  buffer_load_dwordx4 v124, s[16:19], s3 offen offset:2048 lds
  s_waitcnt vmcnt(10)
  ds_write_b128 v252, v[24:27]
  ds_write_b128 v252, v[28:31] offset:4608
  s_mov_b32 s78, 1
  s_branch L_post2
L_codeend:
  s_endpgm
.section .rodata,"a"
.p2align 6
.amdhsa_kernel gated_mix__ssm_conv_s4d__glu_gated_geglu__prompt_kernel
  .amdhsa_next_free_vgpr 512
  .amdhsa_next_free_sgpr 102
  .amdhsa_accum_offset 256
  .amdhsa_group_segment_fixed_size 0
  .amdhsa_kernarg_size 120
  .amdhsa_user_sgpr_count 2
  .amdhsa_user_sgpr_kernarg_segment_ptr 1
  .amdhsa_system_sgpr_workgroup_id_x 1
  .amdhsa_float_denorm_mode_32 3
.end_amdhsa_kernel
```
